```python
import torch

def _softmax(x, axis=-1):
    return torch.softmax(x, dim=axis)
def _gelu(x):
    return torch.nn.functional.gelu(x, approximate="tanh")
def _silu(x):
    return torch.nn.functional.silu(x)
def _sigmoid(x):
    return torch.sigmoid(x)
def _layernorm(x, axis=-1, eps=1e-5):
    m = x.mean(dim=axis, keepdim=True)
    v = x.var(dim=axis, keepdim=True, unbiased=False)
    return (x - m) / torch.sqrt(v + eps)
def _scatter_add(tgt, idx, src, axis=0):
    return tgt.clone().index_add_(axis, idx, src)
def _segment_sum(src, seg, n):
    out = torch.zeros((n,) + src.shape[1:], dtype=src.dtype)
    return out.index_add_(0, seg, src)
def _pad(x, pw):
    flat = tuple(v for pair in reversed(pw) for v in pair)
    return torch.nn.functional.pad(x, flat)

kernel_name = 'parallel_sum__softmax_full_mha__mixer_token_mlp__prompt'

def setup_inputs():

    _w = (lambda a: (lambda t: t.to(torch.bfloat16) if t.is_floating_point() else t)(torch.as_tensor(a)))
    def _A_setup():
        B, S, D = 1, 2048, 448
        return {
            "x": _w((lambda *s: torch.randn(*s, dtype=torch.bfloat16) * 0.05)(B, S, D)),
            "wqkv": _w((lambda *s: torch.randn(*s, dtype=torch.bfloat16) * 0.05)(D, 3 * D)),
            "wo": _w((lambda *s: torch.randn(*s, dtype=torch.bfloat16) * 0.05)(D, D)),
        }
    _A_in = _A_setup()

    def _B_setup():
        B, S, D, F = 1, 2048, 448, 1792
        return {
            "x": _w((lambda *s: torch.randn(*s, dtype=torch.bfloat16) * 0.05)(B, S, D)),
            "w1": _w((lambda *s: torch.randn(*s, dtype=torch.bfloat16) * 0.8)(S, F) * (S ** -0.5)),
            "b1": _w((lambda *s: torch.randn(*s, dtype=torch.bfloat16) * 12.8)(F) * 0.02),
            "w2": _w((lambda *s: torch.randn(*s, dtype=torch.bfloat16) * 0.2)(F, S) * (F ** -0.5)),
            "b2": _w((lambda *s: torch.randn(*s, dtype=torch.bfloat16) * 1.6)(S) * 0.02),
        }
    _B_in = _B_setup()

    return {
        "A_x": _A_in["x"],
        "A_wqkv": _A_in["wqkv"],
        "A_wo": _A_in["wo"],
        "B_x": _B_in["x"],
        "B_w1": _B_in["w1"],
        "B_b1": _B_in["b1"],
        "B_w2": _B_in["w2"],
        "B_b2": _B_in["b2"],
    }

def reference(A_x, A_wqkv, A_wo, B_x, B_w1, B_b1, B_w2, B_b2):
    def _A_ref(x, wqkv, wo):
        B, S, D = x.shape
        H = 16; Dh = D // H
        qkv = (lambda x, *d: x.permute(*d))((x @ wqkv).reshape(B, S, 3, H, Dh), 2, 0, 3, 1, 4)
        q, k, v = qkv[0], qkv[1], qkv[2]
        scale = Dh ** -0.5
        scores = torch.einsum("bhqd,bhkd->bhqk", q, k) * scale
        p = _softmax(scores, axis=-1)
        o = torch.einsum("bhqk,bhkd->bhqd", p, v)
        return (lambda x, *d: x.permute(*d))(o, 0, 2, 1, 3).reshape(B, S, D) @ wo

    def _B_ref(x, w1, b1, w2, b2):
        B, S, D = x.shape
        h = _layernorm(x, axis=-1)
        u = torch.einsum("bsd,sf->bdf", h, w1) + b1
        u = _gelu(u)
        y = torch.einsum("bdf,fs->bds", u, w2) + b2
        return (lambda x, *d: x.permute(*d))(y, 0, 2, 1)

    x = A_x
    xn = _layernorm(x, axis=-1)
    return x + _A_ref(xn, A_wqkv, A_wo) + _B_ref(xn, B_w1, B_b1, B_w2, B_b2)
```

```asm
; @launch grid=(512,1,1) block=(512,1,1) lds=81920
.amdgcn_target "amdgcn-amd-amdhsa--gfx950"
.text
.globl parallel_sum__softmax_full_mha__mixer_token_mlp__prompt_kernel
.p2align 8
.type parallel_sum__softmax_full_mha__mixer_token_mlp__prompt_kernel,@function
parallel_sum__softmax_full_mha__mixer_token_mlp__prompt_kernel:
    s_cmp_ge_u32 s2, 512
    s_cbranch_scc1 exit0
    s_load_dwordx16 s[4:19], s[0:1], 0
    s_load_dwordx4 s[20:23], s[0:1], 64
    s_load_dwordx2 s[24:25], s[0:1], 80
    s_getpc_b64 s[26:27]
k_pc:
    s_sub_u32 s26, s26, k_pc-parallel_sum__softmax_full_mha__mixer_token_mlp__prompt_kernel
    s_subb_u32 s27, s27, 0
    s_lshr_b32 s3, s2, 3
    s_lshl_b32 s3, s3, 10
    s_add_u32 s26, s26, s3
    s_addc_u32 s27, s27, 0
    v_subrev_u32 v2, 504, v0
    v_lshlrev_b32 v2, 7, v2
    v_mov_b32 v3, s27
    v_add_co_u32 v2, vcc, s26, v2
    s_nop 1
    v_addc_co_u32 v3, vcc, 0, v3, vcc
    s_cmp_lt_u32 s3, k_end-parallel_sum__softmax_full_mha__mixer_token_mlp__prompt_kernel-1023
    s_cselect_b64 s[26:27], -1, 0
    v_cmp_le_u32 vcc, 504, v0
    s_and_b64 vcc, vcc, s[26:27]
    s_and_saveexec_b64 s[26:27], vcc
    s_cbranch_execz k_notouch
    global_load_dword v127, v[2:3], off
k_notouch:
    s_mov_b64 exec, s[26:27]
    v_lshrrev_b32 v1, 6, v0
    s_nop 0
    v_readfirstlane_b32 s26, v1
    v_and_b32 v1, 63, v0
    s_cmp_ge_u32 s2, 256
    s_cbranch_scc1 role_a
    s_setprio 2
    s_bitcmp1_b32 s2, 3
    s_cbranch_scc1 b_noln
    s_cmp_lg_u32 s2, 0
    s_cbranch_scc1 b_ln
    s_cmp_lg_u32 s26, 4
    s_cbranch_scc1 b_ln
    s_waitcnt lgkmcnt(0)
    s_mov_b32 s40, s22
    s_mov_b32 s41, s23
    s_mov_b32 s42, 256
    s_mov_b32 s43, 0x20000
    s_memrealtime s[46:47]
    v_mov_b32 v41, 0
    s_waitcnt lgkmcnt(0)
    s_or_b32 s46, s46, 1
    v_mov_b32 v40, s46
    s_mov_b64 exec, 1
    buffer_store_dword v40, v41, s[40:43], 0 offen sc1
    s_mov_b64 exec, -1
b_ln:
    s_lshr_b32 s3, s2, 4
    s_lshl_b32 s3, s3, 3
    s_and_b32 s53, s2, 7
    s_add_u32 s3, s3, s53
    s_lshl_b32 s53, s3, 3
    s_add_u32 s53, s53, s26
    s_mul_i32 s53, s53, 1792
    v_lshlrev_b32 v31, 4, v1
    s_waitcnt lgkmcnt(0)
    s_mov_b32 s28, s4
    s_mov_b32 s29, s5
    s_mov_b32 s30, 1835008
    s_mov_b32 s31, 0x20000
    s_mov_b32 exec_hi, 0x00ffffff
    buffer_load_dwordx4 v[2:5], v31, s[28:31], s53 offen
    buffer_load_dwordx4 v[6:9], v31, s[28:31], s53 offen offset:896
    s_mov_b32 exec_hi, -1
    s_branch role_b2
role_a:
    s_sub_u32 s3, s2, 256
    s_and_b32 s53, s3, 7
    s_lshr_b32 s54, s3, 3
    s_lshr_b32 s55, s53, 1
    s_lshl_b32 s55, s55, 2
    s_and_b32 s56, s54, 3
    s_add_u32 s27, s55, s56
    s_and_b32 s53, s53, 1
    s_lshl_b32 s53, s53, 3
    s_lshr_b32 s54, s54, 2
    s_add_u32 s48, s53, s54
    s_setprio 1
    s_cmp_ge_u32 s26, 4
    s_cbranch_scc1 a_help
    s_lshl_b32 s53, s27, 2
    s_add_u32 s57, s53, s26
    s_mul_i32 s49, s57, 28672
    s_lshl_b32 s51, s26, 12
    s_add_u32 s51, s51, 0
    v_lshrrev_b32 v2, 3, v1
    v_and_b32 v3, 7, v1
    v_lshrrev_b32 v4, 1, v2
    v_xor_b32 v3, v3, v4
    v_lshlrev_b32 v3, 4, v3
    v_mul_u32_u24 v2, 896, v2
    v_add_u32 v42, v2, v3
    v_xor_b32 v3, 64, v3
    v_add_u32 v2, v2, v3
    v_add_u32 v43, 6144, v2
    v_add_u32 v44, 12288, v42
    v_add_u32 v45, 18432, v2
    s_waitcnt lgkmcnt(0)
    s_mov_b32 s28, s4
    s_mov_b32 s29, s5
    s_mov_b32 s30, 1835008
    s_mov_b32 s31, 0x20000
    s_mov_b32 s36, s24
    s_mov_b32 s37, s25
    s_mov_b32 s38, 16777216
    s_mov_b32 s39, 0x20000
    s_add_u32 m0, s51, 0
    s_nop 0
    buffer_load_dwordx4 v42, s[28:31], s49 offen offset:0 lds
    buffer_load_dwordx4 v43, s[28:31], s49 offen offset:1024 lds
    buffer_load_dwordx4 v44, s[28:31], s49 offen offset:2048 lds
    buffer_load_dwordx4 v45, s[28:31], s49 offen offset:3072 lds
    s_add_u32 s49, s49, 128
    s_add_u32 m0, s51, 16384
    s_nop 0
    buffer_load_dwordx4 v42, s[28:31], s49 offen offset:0 lds
    buffer_load_dwordx4 v43, s[28:31], s49 offen offset:1024 lds
    buffer_load_dwordx4 v44, s[28:31], s49 offen offset:2048 lds
    buffer_load_dwordx4 v45, s[28:31], s49 offen offset:3072 lds
    s_add_u32 s49, s49, 128
    s_branch a_comp2
a_help:
    s_lshl_b32 s58, s48, 4
    s_add_u32 s58, s58, s27
    s_lshl_b32 s58, s58, 7
    s_add_u32 s58, s58, 12615680
    s_and_b32 s54, s3, 7
    s_lshl_b32 s54, s54, 1
    s_lshr_b32 s55, s3, 7
    s_add_u32 s54, s54, s55
    s_bfe_u32 s55, s3, 0x40003
    s_lshl_b32 s55, s55, 4
    s_add_u32 s54, s54, s55
    s_lshl_b32 s54, s54, 7
    s_add_u32 s59, s54, 12681216
    v_mov_b32 v43, 0
    s_and_b32 s55, s26, 3
    s_mul_i32 s50, s55, 43008
    s_mul_i32 s53, s48, 168
    s_add_u32 s50, s50, s53
    s_mul_i32 s52, s55, 3072
    s_add_u32 s52, s52, 32768
    v_add_u32 v2, 0, v1
    v_mul_u32_u24 v3, 43691, v2
    v_lshrrev_b32 v3, 19, v3
    v_mul_u32_u24 v4, 12, v3
    v_sub_u32 v4, v2, v4
    v_min_u32 v4, 10, v4
    v_mul_u32_u24 v3, 2688, v3
    v_lshl_add_u32 v3, v4, 4, v3
    v_subrev_u32 v46, 0, v3
    v_add_u32 v2, 64, v1
    v_mul_u32_u24 v3, 43691, v2
    v_lshrrev_b32 v3, 19, v3
    v_mul_u32_u24 v4, 12, v3
    v_sub_u32 v4, v2, v4
    v_min_u32 v4, 10, v4
    v_mul_u32_u24 v3, 2688, v3
    v_lshl_add_u32 v3, v4, 4, v3
    v_subrev_u32 v47, 1024, v3
    v_add_u32 v2, 128, v1
    v_mul_u32_u24 v3, 43691, v2
    v_lshrrev_b32 v3, 19, v3
    v_mul_u32_u24 v4, 12, v3
    v_sub_u32 v4, v2, v4
    v_min_u32 v4, 10, v4
    v_mul_u32_u24 v3, 2688, v3
    v_lshl_add_u32 v3, v4, 4, v3
    v_subrev_u32 v48, 2048, v3
    s_waitcnt lgkmcnt(0)
    s_mov_b32 s32, s6
    s_mov_b32 s33, s7
    s_mov_b32 s34, 1204224
    s_mov_b32 s35, 0x20000
    s_mov_b32 s36, s24
    s_mov_b32 s37, s25
    s_mov_b32 s38, 16777216
    s_mov_b32 s39, 0x20000
    s_cmp_lg_u32 s26, 4
    s_cbranch_scc1 a_nopw
    v_lshlrev_b32 v41, 2, v1
    s_mov_b32 exec_hi, 0
    buffer_store_dword v43, v41, s[36:39], s58 offen sc1
    s_mov_b32 exec_hi, -1
    v_lshlrev_b32 v41, 2, v1
    s_mov_b32 exec_hi, 0
    buffer_store_dword v43, v41, s[36:39], s59 offen sc1
    s_mov_b32 exec_hi, -1
a_nopw:
    s_add_u32 m0, s52, 0
    s_nop 0
    buffer_load_dwordx4 v46, s[32:35], s50 offen offset:0 lds
    buffer_load_dwordx4 v47, s[32:35], s50 offen offset:1024 lds
    buffer_load_dwordx4 v48, s[32:35], s50 offen offset:2048 lds
    s_add_u32 s50, s50, 172032
    s_add_u32 m0, s52, 12288
    s_nop 0
    buffer_load_dwordx4 v46, s[32:35], s50 offen offset:0 lds
    buffer_load_dwordx4 v47, s[32:35], s50 offen offset:1024 lds
    buffer_load_dwordx4 v48, s[32:35], s50 offen offset:2048 lds
    s_add_u32 s50, s50, 172032
    s_branch a_help2
role_b2:
    s_mov_b32 s36, s24
    s_mov_b32 s37, s25
    s_mov_b32 s38, 16777216
    s_mov_b32 s39, 0x20000
    s_mul_i32 s54, s26, 1920
    v_add_u32 v32, s54, v31
    v_mov_b32 v26, 0
    v_mov_b32 v27, 0
    v_mov_b32 v28, 0
    v_mov_b32 v29, 0
    s_mov_b32 exec_hi, 0x00ffffff
    s_waitcnt vmcnt(0)
    v_lshlrev_b32 v10, 16, v2
    v_and_b32 v11, 0xffff0000, v2
    v_lshlrev_b32 v18, 16, v6
    v_and_b32 v19, 0xffff0000, v6
    v_lshlrev_b32 v12, 16, v3
    v_and_b32 v13, 0xffff0000, v3
    v_lshlrev_b32 v20, 16, v7
    v_and_b32 v21, 0xffff0000, v7
    v_lshlrev_b32 v14, 16, v4
    v_and_b32 v15, 0xffff0000, v4
    v_lshlrev_b32 v22, 16, v8
    v_and_b32 v23, 0xffff0000, v8
    v_lshlrev_b32 v16, 16, v5
    v_and_b32 v17, 0xffff0000, v5
    v_lshlrev_b32 v24, 16, v9
    v_and_b32 v25, 0xffff0000, v9
    v_add_f32 v26, v26, v10
    v_fmac_f32 v27, v10, v10
    v_add_f32 v28, v28, v18
    v_fmac_f32 v29, v18, v18
    v_add_f32 v26, v26, v11
    v_fmac_f32 v27, v11, v11
    v_add_f32 v28, v28, v19
    v_fmac_f32 v29, v19, v19
    v_add_f32 v26, v26, v12
    v_fmac_f32 v27, v12, v12
    v_add_f32 v28, v28, v20
    v_fmac_f32 v29, v20, v20
    v_add_f32 v26, v26, v13
    v_fmac_f32 v27, v13, v13
    v_add_f32 v28, v28, v21
    v_fmac_f32 v29, v21, v21
    v_add_f32 v26, v26, v14
    v_fmac_f32 v27, v14, v14
    v_add_f32 v28, v28, v22
    v_fmac_f32 v29, v22, v22
    v_add_f32 v26, v26, v15
    v_fmac_f32 v27, v15, v15
    v_add_f32 v28, v28, v23
    v_fmac_f32 v29, v23, v23
    v_add_f32 v26, v26, v16
    v_fmac_f32 v27, v16, v16
    v_add_f32 v28, v28, v24
    v_fmac_f32 v29, v24, v24
    v_add_f32 v26, v26, v17
    v_fmac_f32 v27, v17, v17
    v_add_f32 v28, v28, v25
    v_fmac_f32 v29, v25, v25
    s_mov_b32 exec_hi, -1
    s_cmp_lg_u32 s26, 4
    s_cbranch_scc1 b_nopw1
    s_lshr_b32 s54, s2, 3
    s_and_b32 s53, s2, 1
    s_mul_i32 s52, s53, 25
    s_add_u32 s52, s52, s54
    s_mul_i32 s51, s52, 9363
    s_lshr_b32 s51, s51, 16
    s_mul_i32 s50, s51, 7
    s_sub_u32 s52, s52, s50
    s_bfe_u32 s50, s2, 0x20001
    s_mul_i32 s50, s50, 7
    s_add_u32 s50, s50, s52
    s_add_u32 s54, s54, s53
    s_cmp_ge_u32 s54, 25
    s_cselect_b32 s55, 1, 0
    s_lshl_b32 s44, s51, 5
    s_add_u32 s44, s44, s50
    s_lshl_b32 s44, s44, 7
    s_add_u32 s44, s44, 12648448
    s_and_b32 s53, s2, 7
    s_lshl_b32 s53, s53, 7
    s_add_u32 s53, s53, 12713984
    s_cmp_ge_u32 s2, 248
    s_cselect_b32 s53, s53, 1073741824
    s_and_b32 s54, s2, 7
    s_lshl_b32 s54, s54, 1
    s_bfe_u32 s56, s2, 0x10003
    s_add_u32 s54, s54, s56
    s_lshl_b32 s54, s54, 7
    s_add_u32 s54, s54, 12716032
    s_lshr_b32 s56, s2, 4
    s_cmp_eq_u32 s56, 14
    s_cselect_b32 s53, s54, s53
    s_cmp_eq_u32 s55, 1
    s_cselect_b32 s44, s53, s44
    s_lshl_b32 s55, s3, 7
    s_add_u32 s55, s55, 12582912
    v_mov_b32 v43, 0
    v_lshlrev_b32 v41, 2, v1
    s_mov_b32 exec_hi, 0
    buffer_store_dword v43, v41, s[36:39], s44 offen sc1
    s_mov_b32 exec_hi, -1
    v_lshlrev_b32 v41, 2, v1
    s_mov_b32 exec_hi, 0
    buffer_store_dword v43, v41, s[36:39], s55 offen sc1
    s_mov_b32 exec_hi, -1
b_nopw1:
    v_add_f32_dpp v26, v26, v26 row_shr:1 row_mask:0xf bank_mask:0xf bound_ctrl:1
    v_add_f32_dpp v27, v27, v27 row_shr:1 row_mask:0xf bank_mask:0xf bound_ctrl:1
    v_add_f32_dpp v28, v28, v28 row_shr:1 row_mask:0xf bank_mask:0xf bound_ctrl:1
    v_add_f32_dpp v29, v29, v29 row_shr:1 row_mask:0xf bank_mask:0xf bound_ctrl:1
    v_add_f32_dpp v26, v26, v26 row_shr:2 row_mask:0xf bank_mask:0xf bound_ctrl:1
    v_add_f32_dpp v27, v27, v27 row_shr:2 row_mask:0xf bank_mask:0xf bound_ctrl:1
    v_add_f32_dpp v28, v28, v28 row_shr:2 row_mask:0xf bank_mask:0xf bound_ctrl:1
    v_add_f32_dpp v29, v29, v29 row_shr:2 row_mask:0xf bank_mask:0xf bound_ctrl:1
    v_add_f32_dpp v26, v26, v26 row_shr:4 row_mask:0xf bank_mask:0xf bound_ctrl:1
    v_add_f32_dpp v27, v27, v27 row_shr:4 row_mask:0xf bank_mask:0xf bound_ctrl:1
    v_add_f32_dpp v28, v28, v28 row_shr:4 row_mask:0xf bank_mask:0xf bound_ctrl:1
    v_add_f32_dpp v29, v29, v29 row_shr:4 row_mask:0xf bank_mask:0xf bound_ctrl:1
    v_add_f32_dpp v26, v26, v26 row_shr:8 row_mask:0xf bank_mask:0xf bound_ctrl:1
    v_add_f32_dpp v27, v27, v27 row_shr:8 row_mask:0xf bank_mask:0xf bound_ctrl:1
    v_add_f32_dpp v28, v28, v28 row_shr:8 row_mask:0xf bank_mask:0xf bound_ctrl:1
    v_add_f32_dpp v29, v29, v29 row_shr:8 row_mask:0xf bank_mask:0xf bound_ctrl:1
    v_add_f32_dpp v26, v26, v26 row_bcast:15 row_mask:0xa bank_mask:0xf
    v_add_f32_dpp v27, v27, v27 row_bcast:15 row_mask:0xa bank_mask:0xf
    v_add_f32_dpp v28, v28, v28 row_bcast:15 row_mask:0xa bank_mask:0xf
    v_add_f32_dpp v29, v29, v29 row_bcast:15 row_mask:0xa bank_mask:0xf
    v_add_f32_dpp v26, v26, v26 row_bcast:31 row_mask:0xc bank_mask:0xf
    v_add_f32_dpp v27, v27, v27 row_bcast:31 row_mask:0xc bank_mask:0xf
    v_add_f32_dpp v28, v28, v28 row_bcast:31 row_mask:0xc bank_mask:0xf
    v_add_f32_dpp v29, v29, v29 row_bcast:31 row_mask:0xc bank_mask:0xf
    v_readlane_b32 s60, v26, 63
    v_readlane_b32 s61, v27, 63
    v_readlane_b32 s62, v28, 63
    v_readlane_b32 s63, v29, 63
    v_mov_b32 v33, 0x3b124925
    v_mul_f32 v38, s61, v33
    v_mul_f32 v33, s60, v33
    v_fma_f32 v38, -v33, v33, v38
    v_max_f32 v38, 0, v38
    v_add_f32 v34, 0x3727c5ac, v38
    v_rsq_f32 v34, v34
    v_mov_b32 v35, 0x3b124925
    v_mul_f32 v39, s63, v35
    v_mul_f32 v35, s62, v35
    v_fma_f32 v39, -v35, v35, v39
    v_max_f32 v39, 0, v39
    v_add_f32 v36, 0x3727c5ac, v39
    v_rsq_f32 v36, v36
    v_mul_f32 v38, v38, v34
    v_mul_f32 v33, v33, v34
    v_mul_f32 v38, v38, v34
    v_sub_f32 v33, 0, v33
    v_add_f32 v38, 0x3727c5ac, v38
    v_rsq_f32 v38, v38
    v_mul_f32 v39, v39, v36
    v_mul_f32 v35, v35, v36
    v_mul_f32 v39, v39, v36
    v_sub_f32 v35, 0, v35
    v_add_f32 v39, 0x3727c5ac, v39
    v_rsq_f32 v39, v39
    s_lshl_b32 s54, s26, 3
    v_mov_b32 v37, s54
    s_mov_b64 exec, 1
    ds_write2_b32 v37, v34, v36 offset0:0 offset1:1
    ds_write2_b32 v37, v33, v35 offset0:16 offset1:17
    s_mov_b64 exec, -1
    v_mul_f32 v26, v33, v38
    v_mul_f32 v27, v34, v38
    v_mul_f32 v28, v35, v39
    v_mul_f32 v29, v36, v39
    v_fma_f32 v10, v10, v27, v26
    v_fma_f32 v11, v11, v27, v26
    v_cvt_pk_bf16_f32 v2, v10, v11
    v_fma_f32 v12, v12, v27, v26
    v_fma_f32 v13, v13, v27, v26
    v_cvt_pk_bf16_f32 v3, v12, v13
    v_fma_f32 v14, v14, v27, v26
    v_fma_f32 v15, v15, v27, v26
    v_cvt_pk_bf16_f32 v4, v14, v15
    v_fma_f32 v16, v16, v27, v26
    v_fma_f32 v17, v17, v27, v26
    v_cvt_pk_bf16_f32 v5, v16, v17
    v_fma_f32 v18, v18, v29, v28
    v_fma_f32 v19, v19, v29, v28
    v_cvt_pk_bf16_f32 v6, v18, v19
    v_fma_f32 v20, v20, v29, v28
    v_fma_f32 v21, v21, v29, v28
    v_cvt_pk_bf16_f32 v7, v20, v21
    v_fma_f32 v22, v22, v29, v28
    v_fma_f32 v23, v23, v29, v28
    v_cvt_pk_bf16_f32 v8, v22, v23
    v_fma_f32 v24, v24, v29, v28
    v_fma_f32 v25, v25, v29, v28
    v_cvt_pk_bf16_f32 v9, v24, v25
    s_mov_b32 exec_hi, 0x00ffffff
    ds_write_b128 v32, v[2:5] offset:128
    ds_write_b128 v32, v[6:9] offset:1088
    s_mov_b32 exec_hi, -1
    v_bfe_u32 v10, v1, 2, 2
    v_mul_u32_u24 v10, 960, v10
    v_lshrrev_b32 v11, 4, v1
    v_lshl_add_u32 v10, v11, 5, v10
    v_and_b32 v11, 3, v1
    v_lshl_add_u32 v10, v11, 3, v10
    s_and_b32 s55, s26, 3
    s_lshr_b32 s56, s26, 2
    s_lshl_b32 s54, s55, 7
    s_mul_i32 s53, s56, 7680
    s_add_u32 s54, s54, s53
    v_add_u32 v10, s54, v10
    s_lshl_b32 s53, s3, 1
    s_add_u32 s53, s53, s56
    s_mul_i32 s53, s53, 7168
    s_lshl_b32 s54, s55, 10
    s_add_u32 s53, s53, s54
    s_add_u32 s53, s53, 6291456
    s_add_u32 s54, s53, 4096
    s_cmp_eq_u32 s55, 3
    s_cselect_b32 s54, 1073741824, s54
    s_lshl_b32 s55, s3, 7
    s_add_u32 s55, s55, 12845056
    s_cmp_eq_u32 s26, 7
    s_cselect_b32 s55, s55, 1073741824
    v_lshlrev_b32 v11, 2, v1
    s_waitcnt lgkmcnt(0)
    s_barrier
    ds_read_b64_tr_b16 v[12:13], v10 offset:128
    ds_read_b64_tr_b16 v[14:15], v10 offset:3968
    ds_read_b64_tr_b16 v[16:17], v10 offset:640
    ds_read_b64_tr_b16 v[18:19], v10 offset:4480
    ds_read_b32 v20, v11
    s_waitcnt lgkmcnt(3)
    buffer_store_dwordx4 v[12:15], v31, s[36:39], s53 offen sc1
    s_waitcnt lgkmcnt(1)
    buffer_store_dwordx4 v[16:19], v31, s[36:39], s54 offen sc1
    s_waitcnt lgkmcnt(0)
    s_mov_b32 exec_hi, 0
    buffer_store_dword v20, v11, s[36:39], s55 offen sc1
    s_mov_b32 exec_hi, -1
    s_cmp_lg_u32 s26, 4
    s_cbranch_scc1 b_ln2
    s_mov_b32 s40, s22
    s_mov_b32 s41, s23
    s_mov_b32 s42, 256
    s_mov_b32 s43, 0x20000
    v_mov_b32 v41, 0
    s_mov_b32 s45, 200000
b_tag0:
    buffer_load_dword v40, v41, s[40:43], 0 offen sc1
    s_waitcnt vmcnt(0)
    v_cmp_eq_u32 vcc, 0, v40
    s_and_b64 exec, exec, vcc
    s_cbranch_execz b_tag0_ok
    s_sleep 2
    s_sub_u32 s45, s45, 1
    s_cbranch_scc0 b_tag0
b_tag0_ok:
    s_mov_b64 exec, -1
    s_lshl_b32 s44, s3, 7
    s_add_u32 s44, s44, 12582912
b_ln2:
    s_waitcnt vmcnt(0)
    s_barrier
    s_cmp_lg_u32 s26, 4
    s_cbranch_scc1 b_roles
    v_lshlrev_b32 v41, 2, v1
    s_mov_b32 exec_hi, 0
    buffer_store_dword v40, v41, s[36:39], s44 offen sc1
    s_mov_b32 exec_hi, -1
    s_branch b_help
b_noln:
    s_waitcnt lgkmcnt(0)
    s_mov_b32 s36, s24
    s_mov_b32 s37, s25
    s_mov_b32 s38, 16777216
    s_mov_b32 s39, 0x20000
    s_cmp_lt_u32 s26, 4
    s_cbranch_scc1 b_g1
    s_cmp_ge_u32 s26, 6
    s_cbranch_scc1 exit0
    s_cmp_lg_u32 s26, 4
    s_cbranch_scc1 b_nopw0
    s_lshr_b32 s54, s2, 3
    s_and_b32 s53, s2, 1
    s_mul_i32 s52, s53, 25
    s_add_u32 s52, s52, s54
    s_mul_i32 s51, s52, 9363
    s_lshr_b32 s51, s51, 16
    s_mul_i32 s50, s51, 7
    s_sub_u32 s52, s52, s50
    s_bfe_u32 s50, s2, 0x20001
    s_mul_i32 s50, s50, 7
    s_add_u32 s50, s50, s52
    s_add_u32 s54, s54, s53
    s_cmp_ge_u32 s54, 25
    s_cselect_b32 s55, 1, 0
    s_lshl_b32 s44, s51, 5
    s_add_u32 s44, s44, s50
    s_lshl_b32 s44, s44, 7
    s_add_u32 s44, s44, 12648448
    s_and_b32 s53, s2, 7
    s_lshl_b32 s53, s53, 7
    s_add_u32 s53, s53, 12713984
    s_cmp_ge_u32 s2, 248
    s_cselect_b32 s53, s53, 1073741824
    s_and_b32 s54, s2, 7
    s_lshl_b32 s54, s54, 1
    s_bfe_u32 s56, s2, 0x10003
    s_add_u32 s54, s54, s56
    s_lshl_b32 s54, s54, 7
    s_add_u32 s54, s54, 12716032
    s_lshr_b32 s56, s2, 4
    s_cmp_eq_u32 s56, 14
    s_cselect_b32 s53, s54, s53
    s_cmp_eq_u32 s55, 1
    s_cselect_b32 s44, s53, s44
    s_lshl_b32 s55, s3, 7
    s_add_u32 s55, s55, 12582912
    v_mov_b32 v43, 0
    v_lshlrev_b32 v41, 2, v1
    s_mov_b32 exec_hi, 0
    buffer_store_dword v43, v41, s[36:39], s44 offen sc1
    s_mov_b32 exec_hi, -1
b_nopw0:
    s_mov_b32 s40, s22
    s_mov_b32 s41, s23
    s_mov_b32 s42, 256
    s_mov_b32 s43, 0x20000
    v_mov_b32 v41, 0
    s_mov_b32 s45, 200000
b_tag1:
    buffer_load_dword v40, v41, s[40:43], 0 offen sc1
    s_waitcnt vmcnt(0)
    v_cmp_eq_u32 vcc, 0, v40
    s_and_b64 exec, exec, vcc
    s_cbranch_execz b_tag1_ok
    s_sleep 2
    s_sub_u32 s45, s45, 1
    s_cbranch_scc0 b_tag1
b_tag1_ok:
    s_mov_b64 exec, -1
b_roles:
    s_cmp_ge_u32 s26, 6
    s_cbranch_scc1 exit0
    s_cmp_eq_u32 s26, 5
    s_cbranch_scc1 b_pref
    s_cmp_eq_u32 s26, 4
    s_cbranch_scc1 b_help
b_g1:
    s_lshr_b32 s54, s2, 3
    s_and_b32 s53, s2, 1
    s_mul_i32 s52, s53, 25
    s_add_u32 s52, s52, s54
    s_mul_i32 s51, s52, 9363
    s_lshr_b32 s51, s51, 16
    s_mul_i32 s50, s51, 7
    s_sub_u32 s52, s52, s50
    s_bfe_u32 s50, s2, 0x20001
    s_mul_i32 s50, s50, 7
    s_add_u32 s50, s50, s52
    s_add_u32 s54, s54, s53
    s_cmp_ge_u32 s54, 25
    s_cbranch_scc1 b_fin
    s_lshl_b32 s27, s26, 13
    s_mul_i32 s48, s26, 57344
    s_lshl_b32 s53, s50, 7
    s_add_u32 s48, s48, s53
    s_mul_i32 s49, s26, 14336
    s_lshl_b32 s53, s51, 10
    s_add_u32 s49, s49, s53
    s_add_u32 s49, s49, 6291456
    v_lshrrev_b32 v62, 3, v1
    v_and_b32 v63, 7, v1
    v_bfe_u32 v50, v1, 4, 1
    v_lshlrev_b32 v50, 2, v50
    v_xor_b32 v63, v63, v50
    v_mul_u32_u24 v62, 3584, v62
    v_lshl_add_u32 v50, v63, 4, v62
    v_add_u32 v51, 27648, v50
    v_lshrrev_b32 v62, 5, v1
    v_mul_u32_u24 v62, 8, v62
    v_bfe_u32 v63, v1, 2, 2
    v_add_u32 v62, v62, v63
    v_lshlrev_b32 v62, 7, v62
    v_bfe_u32 v63, v1, 3, 1
    v_lshl_add_u32 v62, v63, 6, v62
    v_bfe_u32 v63, v1, 4, 1
    v_lshl_add_u32 v62, v63, 5, v62
    v_and_b32 v63, 3, v1
    v_lshl_add_u32 v62, v63, 3, v62
    v_add_u32 v54, s27, v62
    v_xor_b32 v55, 64, v54
    v_lshrrev_b32 v62, 5, v1
    v_mul_u32_u24 v62, 7168, v62
    v_and_b32 v63, 31, v1
    v_lshl_add_u32 v52, v63, 4, v62
    v_add_u32 v53, 512, v52
    s_waitcnt lgkmcnt(0)
    s_mov_b32 s28, s12
    s_mov_b32 s29, s13
    s_mov_b32 s30, 7340032
    s_mov_b32 s31, 0x20000
    s_mov_b32 s32, s14
    s_mov_b32 s33, s15
    s_mov_b32 s34, 3584
    s_mov_b32 s35, 0x20000
    s_mov_b32 s36, s24
    s_mov_b32 s37, s25
    s_mov_b32 s38, 16777216
    s_mov_b32 s39, 0x20000
    s_lshr_b32 s55, s26, 1
    s_lshl_b32 s53, s50, 1
    s_add_u32 s55, s55, s53
    s_lshl_b32 s53, s55, 6
    v_lshrrev_b32 v2, 5, v1
    v_lshlrev_b32 v2, 3, v2
    buffer_load_dwordx2 v[56:57], v2, s[32:35], s53 offen offset:0
    buffer_load_dwordx2 v[58:59], v2, s[32:35], s53 offen offset:16
    buffer_load_dwordx2 v[60:61], v2, s[32:35], s53 offen offset:32
    buffer_load_dwordx2 v[62:63], v2, s[32:35], s53 offen offset:48
    s_setprio 0
    s_barrier
    s_add_u32 m0, s27, 0
    buffer_load_dwordx4 v[2:5], v52, s[36:39], s49 offen sc1
    buffer_load_dwordx4 v50, s[28:31], s48 offen lds
    buffer_load_dwordx4 v[6:9], v53, s[36:39], s49 offen sc1
    buffer_load_dwordx4 v51, s[28:31], s48 offen offset:1024 lds
    s_add_u32 s48, s48, 229376
    s_add_u32 s49, s49, 57344
    s_add_u32 m0, s27, 2048
    buffer_load_dwordx4 v[10:13], v52, s[36:39], s49 offen sc1
    buffer_load_dwordx4 v50, s[28:31], s48 offen lds
    buffer_load_dwordx4 v[14:17], v53, s[36:39], s49 offen sc1
    buffer_load_dwordx4 v51, s[28:31], s48 offen offset:1024 lds
    s_add_u32 s48, s48, 229376
    s_add_u32 s49, s49, 57344
    s_add_u32 m0, s27, 4096
    buffer_load_dwordx4 v[18:21], v52, s[36:39], s49 offen sc1
    buffer_load_dwordx4 v50, s[28:31], s48 offen lds
    buffer_load_dwordx4 v[22:25], v53, s[36:39], s49 offen sc1
    buffer_load_dwordx4 v51, s[28:31], s48 offen offset:1024 lds
    s_add_u32 s48, s48, 229376
    s_add_u32 s49, s49, 57344
    s_waitcnt vmcnt(8)
    ds_read_b64_tr_b16 v[34:35], v54 offset:0
    ds_read_b64_tr_b16 v[36:37], v54 offset:512
    ds_read_b64_tr_b16 v[38:39], v55 offset:0
    ds_read_b64_tr_b16 v[40:41], v55 offset:512
    s_waitcnt lgkmcnt(0)
    v_mfma_f32_32x32x16_bf16 v[64:79], v[34:37], v[2:5], 0
    s_add_u32 m0, s27, 6144
    buffer_load_dwordx4 v[26:29], v52, s[36:39], s49 offen sc1
    buffer_load_dwordx4 v50, s[28:31], s48 offen lds
    v_mfma_f32_32x32x16_bf16 v[80:95], v[34:37], v[6:9], 0
    buffer_load_dwordx4 v[30:33], v53, s[36:39], s49 offen sc1
    buffer_load_dwordx4 v51, s[28:31], s48 offen offset:1024 lds
    s_add_u32 s48, s48, 229376
    s_add_u32 s49, s49, 57344
    v_mfma_f32_32x32x16_bf16 v[112:127], v[38:41], v[6:9], 0
    s_waitcnt vmcnt(8)
    ds_read_b64_tr_b16 v[42:43], v54 offset:2048
    ds_read_b64_tr_b16 v[44:45], v54 offset:2560
    ds_read_b64_tr_b16 v[46:47], v55 offset:2048
    ds_read_b64_tr_b16 v[48:49], v55 offset:2560
    v_mfma_f32_32x32x16_bf16 v[96:111], v[38:41], v[2:5], 0
    s_waitcnt lgkmcnt(0)
    v_mfma_f32_32x32x16_bf16 v[64:79], v[42:45], v[10:13], v[64:79]
    s_add_u32 m0, s27, 0
    buffer_load_dwordx4 v[2:5], v52, s[36:39], s49 offen sc1
    buffer_load_dwordx4 v50, s[28:31], s48 offen lds
    v_mfma_f32_32x32x16_bf16 v[80:95], v[42:45], v[14:17], v[80:95]
    buffer_load_dwordx4 v[6:9], v53, s[36:39], s49 offen sc1
    buffer_load_dwordx4 v51, s[28:31], s48 offen offset:1024 lds
    s_add_u32 s48, s48, 229376
    s_add_u32 s49, s49, 57344
    v_mfma_f32_32x32x16_bf16 v[112:127], v[46:49], v[14:17], v[112:127]
    s_waitcnt vmcnt(8)
    ds_read_b64_tr_b16 v[34:35], v54 offset:4096
    ds_read_b64_tr_b16 v[36:37], v54 offset:4608
    ds_read_b64_tr_b16 v[38:39], v55 offset:4096
    ds_read_b64_tr_b16 v[40:41], v55 offset:4608
    v_mfma_f32_32x32x16_bf16 v[96:111], v[46:49], v[10:13], v[96:111]
    s_waitcnt lgkmcnt(0)
    v_mfma_f32_32x32x16_bf16 v[64:79], v[34:37], v[18:21], v[64:79]
    s_add_u32 m0, s27, 2048
    buffer_load_dwordx4 v[10:13], v52, s[36:39], s49 offen sc1
    buffer_load_dwordx4 v50, s[28:31], s48 offen lds
    v_mfma_f32_32x32x16_bf16 v[80:95], v[34:37], v[22:25], v[80:95]
    buffer_load_dwordx4 v[14:17], v53, s[36:39], s49 offen sc1
    buffer_load_dwordx4 v51, s[28:31], s48 offen offset:1024 lds
    s_add_u32 s48, s48, 229376
    s_add_u32 s49, s49, 57344
    v_mfma_f32_32x32x16_bf16 v[112:127], v[38:41], v[22:25], v[112:127]
    s_waitcnt vmcnt(8)
    ds_read_b64_tr_b16 v[42:43], v54 offset:6144
    ds_read_b64_tr_b16 v[44:45], v54 offset:6656
    ds_read_b64_tr_b16 v[46:47], v55 offset:6144
    ds_read_b64_tr_b16 v[48:49], v55 offset:6656
    v_mfma_f32_32x32x16_bf16 v[96:111], v[38:41], v[18:21], v[96:111]
    s_waitcnt lgkmcnt(0)
    v_mfma_f32_32x32x16_bf16 v[64:79], v[42:45], v[26:29], v[64:79]
    s_add_u32 m0, s27, 4096
    buffer_load_dwordx4 v[18:21], v52, s[36:39], s49 offen sc1
    buffer_load_dwordx4 v50, s[28:31], s48 offen lds
    v_mfma_f32_32x32x16_bf16 v[80:95], v[42:45], v[30:33], v[80:95]
    buffer_load_dwordx4 v[22:25], v53, s[36:39], s49 offen sc1
    buffer_load_dwordx4 v51, s[28:31], s48 offen offset:1024 lds
    s_add_u32 s48, s48, 229376
    s_add_u32 s49, s49, 57344
    v_mfma_f32_32x32x16_bf16 v[112:127], v[46:49], v[30:33], v[112:127]
    s_waitcnt vmcnt(8)
    ds_read_b64_tr_b16 v[34:35], v54 offset:0
    ds_read_b64_tr_b16 v[36:37], v54 offset:512
    ds_read_b64_tr_b16 v[38:39], v55 offset:0
    ds_read_b64_tr_b16 v[40:41], v55 offset:512
    v_mfma_f32_32x32x16_bf16 v[96:111], v[46:49], v[26:29], v[96:111]
    s_waitcnt lgkmcnt(0)
    v_mfma_f32_32x32x16_bf16 v[64:79], v[34:37], v[2:5], v[64:79]
    s_add_u32 m0, s27, 6144
    buffer_load_dwordx4 v[26:29], v52, s[36:39], s49 offen sc1
    buffer_load_dwordx4 v50, s[28:31], s48 offen lds
    v_mfma_f32_32x32x16_bf16 v[80:95], v[34:37], v[6:9], v[80:95]
    buffer_load_dwordx4 v[30:33], v53, s[36:39], s49 offen sc1
    buffer_load_dwordx4 v51, s[28:31], s48 offen offset:1024 lds
    s_add_u32 s48, s48, 229376
    s_add_u32 s49, s49, 57344
    v_mfma_f32_32x32x16_bf16 v[112:127], v[38:41], v[6:9], v[112:127]
    s_waitcnt vmcnt(8)
    ds_read_b64_tr_b16 v[42:43], v54 offset:2048
    ds_read_b64_tr_b16 v[44:45], v54 offset:2560
    ds_read_b64_tr_b16 v[46:47], v55 offset:2048
    ds_read_b64_tr_b16 v[48:49], v55 offset:2560
    v_mfma_f32_32x32x16_bf16 v[96:111], v[38:41], v[2:5], v[96:111]
    s_waitcnt lgkmcnt(0)
    v_mfma_f32_32x32x16_bf16 v[64:79], v[42:45], v[10:13], v[64:79]
    s_add_u32 m0, s27, 0
    buffer_load_dwordx4 v[2:5], v52, s[36:39], s49 offen sc1
    buffer_load_dwordx4 v50, s[28:31], s48 offen lds
    v_mfma_f32_32x32x16_bf16 v[80:95], v[42:45], v[14:17], v[80:95]
    buffer_load_dwordx4 v[6:9], v53, s[36:39], s49 offen sc1
    buffer_load_dwordx4 v51, s[28:31], s48 offen offset:1024 lds
    s_add_u32 s48, s48, 229376
    s_add_u32 s49, s49, 57344
    v_mfma_f32_32x32x16_bf16 v[112:127], v[46:49], v[14:17], v[112:127]
    s_waitcnt vmcnt(8)
    ds_read_b64_tr_b16 v[34:35], v54 offset:4096
    ds_read_b64_tr_b16 v[36:37], v54 offset:4608
    ds_read_b64_tr_b16 v[38:39], v55 offset:4096
    ds_read_b64_tr_b16 v[40:41], v55 offset:4608
    v_mfma_f32_32x32x16_bf16 v[96:111], v[46:49], v[10:13], v[96:111]
    s_waitcnt lgkmcnt(0)
    v_mfma_f32_32x32x16_bf16 v[64:79], v[34:37], v[18:21], v[64:79]
    s_add_u32 m0, s27, 2048
    buffer_load_dwordx4 v[10:13], v52, s[36:39], s49 offen sc1
    buffer_load_dwordx4 v50, s[28:31], s48 offen lds
    v_mfma_f32_32x32x16_bf16 v[80:95], v[34:37], v[22:25], v[80:95]
    buffer_load_dwordx4 v[14:17], v53, s[36:39], s49 offen sc1
    buffer_load_dwordx4 v51, s[28:31], s48 offen offset:1024 lds
    s_add_u32 s48, s48, 229376
    s_add_u32 s49, s49, 57344
    v_mfma_f32_32x32x16_bf16 v[112:127], v[38:41], v[22:25], v[112:127]
    s_waitcnt vmcnt(8)
    ds_read_b64_tr_b16 v[42:43], v54 offset:6144
    ds_read_b64_tr_b16 v[44:45], v54 offset:6656
    ds_read_b64_tr_b16 v[46:47], v55 offset:6144
    ds_read_b64_tr_b16 v[48:49], v55 offset:6656
    v_mfma_f32_32x32x16_bf16 v[96:111], v[38:41], v[18:21], v[96:111]
    s_waitcnt lgkmcnt(0)
    v_mfma_f32_32x32x16_bf16 v[64:79], v[42:45], v[26:29], v[64:79]
    s_add_u32 m0, s27, 4096
    buffer_load_dwordx4 v[18:21], v52, s[36:39], s49 offen sc1
    buffer_load_dwordx4 v50, s[28:31], s48 offen lds
    v_mfma_f32_32x32x16_bf16 v[80:95], v[42:45], v[30:33], v[80:95]
    buffer_load_dwordx4 v[22:25], v53, s[36:39], s49 offen sc1
    buffer_load_dwordx4 v51, s[28:31], s48 offen offset:1024 lds
    s_add_u32 s48, s48, 229376
    s_add_u32 s49, s49, 57344
    v_mfma_f32_32x32x16_bf16 v[112:127], v[46:49], v[30:33], v[112:127]
    s_waitcnt vmcnt(8)
    ds_read_b64_tr_b16 v[34:35], v54 offset:0
    ds_read_b64_tr_b16 v[36:37], v54 offset:512
    ds_read_b64_tr_b16 v[38:39], v55 offset:0
    ds_read_b64_tr_b16 v[40:41], v55 offset:512
    v_mfma_f32_32x32x16_bf16 v[96:111], v[46:49], v[26:29], v[96:111]
    s_waitcnt lgkmcnt(0)
    v_mfma_f32_32x32x16_bf16 v[64:79], v[34:37], v[2:5], v[64:79]
    s_add_u32 m0, s27, 6144
    buffer_load_dwordx4 v[26:29], v52, s[36:39], s49 offen sc1
    buffer_load_dwordx4 v50, s[28:31], s48 offen lds
    v_mfma_f32_32x32x16_bf16 v[80:95], v[34:37], v[6:9], v[80:95]
    buffer_load_dwordx4 v[30:33], v53, s[36:39], s49 offen sc1
    buffer_load_dwordx4 v51, s[28:31], s48 offen offset:1024 lds
    s_add_u32 s48, s48, 229376
    s_add_u32 s49, s49, 57344
    v_mfma_f32_32x32x16_bf16 v[112:127], v[38:41], v[6:9], v[112:127]
    s_waitcnt vmcnt(8)
    ds_read_b64_tr_b16 v[42:43], v54 offset:2048
    ds_read_b64_tr_b16 v[44:45], v54 offset:2560
    ds_read_b64_tr_b16 v[46:47], v55 offset:2048
    ds_read_b64_tr_b16 v[48:49], v55 offset:2560
    v_mfma_f32_32x32x16_bf16 v[96:111], v[38:41], v[2:5], v[96:111]
    s_waitcnt lgkmcnt(0)
    v_mfma_f32_32x32x16_bf16 v[64:79], v[42:45], v[10:13], v[64:79]
    s_add_u32 m0, s27, 0
    buffer_load_dwordx4 v[2:5], v52, s[36:39], s49 offen sc1
    buffer_load_dwordx4 v50, s[28:31], s48 offen lds
    v_mfma_f32_32x32x16_bf16 v[80:95], v[42:45], v[14:17], v[80:95]
    buffer_load_dwordx4 v[6:9], v53, s[36:39], s49 offen sc1
    buffer_load_dwordx4 v51, s[28:31], s48 offen offset:1024 lds
    s_add_u32 s48, s48, 229376
    s_add_u32 s49, s49, 57344
    v_mfma_f32_32x32x16_bf16 v[112:127], v[46:49], v[14:17], v[112:127]
    s_waitcnt vmcnt(8)
    ds_read_b64_tr_b16 v[34:35], v54 offset:4096
    ds_read_b64_tr_b16 v[36:37], v54 offset:4608
    ds_read_b64_tr_b16 v[38:39], v55 offset:4096
    ds_read_b64_tr_b16 v[40:41], v55 offset:4608
    v_mfma_f32_32x32x16_bf16 v[96:111], v[46:49], v[10:13], v[96:111]
    s_waitcnt lgkmcnt(0)
    v_mfma_f32_32x32x16_bf16 v[64:79], v[34:37], v[18:21], v[64:79]
    s_add_u32 m0, s27, 2048
    buffer_load_dwordx4 v[10:13], v52, s[36:39], s49 offen sc1
    buffer_load_dwordx4 v50, s[28:31], s48 offen lds
    v_mfma_f32_32x32x16_bf16 v[80:95], v[34:37], v[22:25], v[80:95]
    buffer_load_dwordx4 v[14:17], v53, s[36:39], s49 offen sc1
    buffer_load_dwordx4 v51, s[28:31], s48 offen offset:1024 lds
    s_add_u32 s48, s48, 229376
    s_add_u32 s49, s49, 57344
    v_mfma_f32_32x32x16_bf16 v[112:127], v[38:41], v[22:25], v[112:127]
    s_waitcnt vmcnt(8)
    ds_read_b64_tr_b16 v[42:43], v54 offset:6144
    ds_read_b64_tr_b16 v[44:45], v54 offset:6656
    ds_read_b64_tr_b16 v[46:47], v55 offset:6144
    ds_read_b64_tr_b16 v[48:49], v55 offset:6656
    v_mfma_f32_32x32x16_bf16 v[96:111], v[38:41], v[18:21], v[96:111]
    s_waitcnt lgkmcnt(0)
    v_mfma_f32_32x32x16_bf16 v[64:79], v[42:45], v[26:29], v[64:79]
    s_add_u32 m0, s27, 4096
    buffer_load_dwordx4 v[18:21], v52, s[36:39], s49 offen sc1
    buffer_load_dwordx4 v50, s[28:31], s48 offen lds
    v_mfma_f32_32x32x16_bf16 v[80:95], v[42:45], v[30:33], v[80:95]
    buffer_load_dwordx4 v[22:25], v53, s[36:39], s49 offen sc1
    buffer_load_dwordx4 v51, s[28:31], s48 offen offset:1024 lds
    s_add_u32 s48, s48, 229376
    s_add_u32 s49, s49, 57344
    v_mfma_f32_32x32x16_bf16 v[112:127], v[46:49], v[30:33], v[112:127]
    s_waitcnt vmcnt(8)
    ds_read_b64_tr_b16 v[34:35], v54 offset:0
    ds_read_b64_tr_b16 v[36:37], v54 offset:512
    ds_read_b64_tr_b16 v[38:39], v55 offset:0
    ds_read_b64_tr_b16 v[40:41], v55 offset:512
    v_mfma_f32_32x32x16_bf16 v[96:111], v[46:49], v[26:29], v[96:111]
    s_waitcnt lgkmcnt(0)
    v_mfma_f32_32x32x16_bf16 v[64:79], v[34:37], v[2:5], v[64:79]
    s_add_u32 m0, s27, 6144
    buffer_load_dwordx4 v[26:29], v52, s[36:39], s49 offen sc1
    buffer_load_dwordx4 v50, s[28:31], s48 offen lds
    v_mfma_f32_32x32x16_bf16 v[80:95], v[34:37], v[6:9], v[80:95]
    buffer_load_dwordx4 v[30:33], v53, s[36:39], s49 offen sc1
    buffer_load_dwordx4 v51, s[28:31], s48 offen offset:1024 lds
    s_add_u32 s48, s48, 229376
    s_add_u32 s49, s49, 57344
    v_mfma_f32_32x32x16_bf16 v[112:127], v[38:41], v[6:9], v[112:127]
    s_waitcnt vmcnt(8)
    ds_read_b64_tr_b16 v[42:43], v54 offset:2048
    ds_read_b64_tr_b16 v[44:45], v54 offset:2560
    ds_read_b64_tr_b16 v[46:47], v55 offset:2048
    ds_read_b64_tr_b16 v[48:49], v55 offset:2560
    v_mfma_f32_32x32x16_bf16 v[96:111], v[38:41], v[2:5], v[96:111]
    s_waitcnt lgkmcnt(0)
    v_mfma_f32_32x32x16_bf16 v[64:79], v[42:45], v[10:13], v[64:79]
    s_add_u32 m0, s27, 0
    buffer_load_dwordx4 v[2:5], v52, s[36:39], s49 offen sc1
    buffer_load_dwordx4 v50, s[28:31], s48 offen lds
    v_mfma_f32_32x32x16_bf16 v[80:95], v[42:45], v[14:17], v[80:95]
    buffer_load_dwordx4 v[6:9], v53, s[36:39], s49 offen sc1
    buffer_load_dwordx4 v51, s[28:31], s48 offen offset:1024 lds
    s_add_u32 s48, s48, 229376
    s_add_u32 s49, s49, 57344
    v_mfma_f32_32x32x16_bf16 v[112:127], v[46:49], v[14:17], v[112:127]
    s_waitcnt vmcnt(8)
    ds_read_b64_tr_b16 v[34:35], v54 offset:4096
    ds_read_b64_tr_b16 v[36:37], v54 offset:4608
    ds_read_b64_tr_b16 v[38:39], v55 offset:4096
    ds_read_b64_tr_b16 v[40:41], v55 offset:4608
    v_mfma_f32_32x32x16_bf16 v[96:111], v[46:49], v[10:13], v[96:111]
    s_waitcnt lgkmcnt(0)
    v_mfma_f32_32x32x16_bf16 v[64:79], v[34:37], v[18:21], v[64:79]
    s_add_u32 m0, s27, 2048
    buffer_load_dwordx4 v[10:13], v52, s[36:39], s49 offen sc1
    buffer_load_dwordx4 v50, s[28:31], s48 offen lds
    v_mfma_f32_32x32x16_bf16 v[80:95], v[34:37], v[22:25], v[80:95]
    buffer_load_dwordx4 v[14:17], v53, s[36:39], s49 offen sc1
    buffer_load_dwordx4 v51, s[28:31], s48 offen offset:1024 lds
    s_add_u32 s48, s48, 229376
    s_add_u32 s49, s49, 57344
    v_mfma_f32_32x32x16_bf16 v[112:127], v[38:41], v[22:25], v[112:127]
    s_waitcnt vmcnt(8)
    ds_read_b64_tr_b16 v[42:43], v54 offset:6144
    ds_read_b64_tr_b16 v[44:45], v54 offset:6656
    ds_read_b64_tr_b16 v[46:47], v55 offset:6144
    ds_read_b64_tr_b16 v[48:49], v55 offset:6656
    v_mfma_f32_32x32x16_bf16 v[96:111], v[38:41], v[18:21], v[96:111]
    s_waitcnt lgkmcnt(0)
    v_mfma_f32_32x32x16_bf16 v[64:79], v[42:45], v[26:29], v[64:79]
    s_add_u32 m0, s27, 4096
    buffer_load_dwordx4 v[18:21], v52, s[36:39], s49 offen sc1
    buffer_load_dwordx4 v50, s[28:31], s48 offen lds
    v_mfma_f32_32x32x16_bf16 v[80:95], v[42:45], v[30:33], v[80:95]
    buffer_load_dwordx4 v[22:25], v53, s[36:39], s49 offen sc1
    buffer_load_dwordx4 v51, s[28:31], s48 offen offset:1024 lds
    s_add_u32 s48, s48, 229376
    s_add_u32 s49, s49, 57344
    v_mfma_f32_32x32x16_bf16 v[112:127], v[46:49], v[30:33], v[112:127]
    s_waitcnt vmcnt(8)
    ds_read_b64_tr_b16 v[34:35], v54 offset:0
    ds_read_b64_tr_b16 v[36:37], v54 offset:512
    ds_read_b64_tr_b16 v[38:39], v55 offset:0
    ds_read_b64_tr_b16 v[40:41], v55 offset:512
    v_mfma_f32_32x32x16_bf16 v[96:111], v[46:49], v[26:29], v[96:111]
    s_waitcnt lgkmcnt(0)
    v_mfma_f32_32x32x16_bf16 v[64:79], v[34:37], v[2:5], v[64:79]
    s_add_u32 m0, s27, 6144
    buffer_load_dwordx4 v[26:29], v52, s[36:39], s49 offen sc1
    buffer_load_dwordx4 v50, s[28:31], s48 offen lds
    v_mfma_f32_32x32x16_bf16 v[80:95], v[34:37], v[6:9], v[80:95]
    buffer_load_dwordx4 v[30:33], v53, s[36:39], s49 offen sc1
    buffer_load_dwordx4 v51, s[28:31], s48 offen offset:1024 lds
    s_add_u32 s48, s48, 229376
    s_add_u32 s49, s49, 57344
    v_mfma_f32_32x32x16_bf16 v[112:127], v[38:41], v[6:9], v[112:127]
    s_waitcnt vmcnt(8)
    ds_read_b64_tr_b16 v[42:43], v54 offset:2048
    ds_read_b64_tr_b16 v[44:45], v54 offset:2560
    ds_read_b64_tr_b16 v[46:47], v55 offset:2048
    ds_read_b64_tr_b16 v[48:49], v55 offset:2560
    v_mfma_f32_32x32x16_bf16 v[96:111], v[38:41], v[2:5], v[96:111]
    s_waitcnt lgkmcnt(0)
    v_mfma_f32_32x32x16_bf16 v[64:79], v[42:45], v[10:13], v[64:79]
    s_add_u32 m0, s27, 0
    buffer_load_dwordx4 v[2:5], v52, s[36:39], s49 offen sc1
    buffer_load_dwordx4 v50, s[28:31], s48 offen lds
    v_mfma_f32_32x32x16_bf16 v[80:95], v[42:45], v[14:17], v[80:95]
    buffer_load_dwordx4 v[6:9], v53, s[36:39], s49 offen sc1
    buffer_load_dwordx4 v51, s[28:31], s48 offen offset:1024 lds
    s_add_u32 s48, s48, 229376
    s_add_u32 s49, s49, 57344
    v_mfma_f32_32x32x16_bf16 v[112:127], v[46:49], v[14:17], v[112:127]
    s_waitcnt vmcnt(8)
    ds_read_b64_tr_b16 v[34:35], v54 offset:4096
    ds_read_b64_tr_b16 v[36:37], v54 offset:4608
    ds_read_b64_tr_b16 v[38:39], v55 offset:4096
    ds_read_b64_tr_b16 v[40:41], v55 offset:4608
    v_mfma_f32_32x32x16_bf16 v[96:111], v[46:49], v[10:13], v[96:111]
    s_waitcnt lgkmcnt(0)
    v_mfma_f32_32x32x16_bf16 v[64:79], v[34:37], v[18:21], v[64:79]
    s_add_u32 m0, s27, 2048
    buffer_load_dwordx4 v[10:13], v52, s[36:39], s49 offen sc1
    buffer_load_dwordx4 v50, s[28:31], s48 offen lds
    v_mfma_f32_32x32x16_bf16 v[80:95], v[34:37], v[22:25], v[80:95]
    buffer_load_dwordx4 v[14:17], v53, s[36:39], s49 offen sc1
    buffer_load_dwordx4 v51, s[28:31], s48 offen offset:1024 lds
    s_add_u32 s48, s48, 229376
    s_add_u32 s49, s49, 57344
    v_mfma_f32_32x32x16_bf16 v[112:127], v[38:41], v[22:25], v[112:127]
    s_waitcnt vmcnt(8)
    ds_read_b64_tr_b16 v[42:43], v54 offset:6144
    ds_read_b64_tr_b16 v[44:45], v54 offset:6656
    ds_read_b64_tr_b16 v[46:47], v55 offset:6144
    ds_read_b64_tr_b16 v[48:49], v55 offset:6656
    v_mfma_f32_32x32x16_bf16 v[96:111], v[38:41], v[18:21], v[96:111]
    s_waitcnt lgkmcnt(0)
    v_mfma_f32_32x32x16_bf16 v[64:79], v[42:45], v[26:29], v[64:79]
    s_add_u32 m0, s27, 4096
    buffer_load_dwordx4 v[18:21], v52, s[36:39], s49 offen sc1
    buffer_load_dwordx4 v50, s[28:31], s48 offen lds
    v_mfma_f32_32x32x16_bf16 v[80:95], v[42:45], v[30:33], v[80:95]
    buffer_load_dwordx4 v[22:25], v53, s[36:39], s49 offen sc1
    buffer_load_dwordx4 v51, s[28:31], s48 offen offset:1024 lds
    s_add_u32 s48, s48, 229376
    s_add_u32 s49, s49, 57344
    v_mfma_f32_32x32x16_bf16 v[112:127], v[46:49], v[30:33], v[112:127]
    s_waitcnt vmcnt(8)
    ds_read_b64_tr_b16 v[34:35], v54 offset:0
    ds_read_b64_tr_b16 v[36:37], v54 offset:512
    ds_read_b64_tr_b16 v[38:39], v55 offset:0
    ds_read_b64_tr_b16 v[40:41], v55 offset:512
    v_mfma_f32_32x32x16_bf16 v[96:111], v[46:49], v[26:29], v[96:111]
    s_waitcnt lgkmcnt(0)
    v_mfma_f32_32x32x16_bf16 v[64:79], v[34:37], v[2:5], v[64:79]
    s_add_u32 m0, s27, 6144
    buffer_load_dwordx4 v[26:29], v52, s[36:39], s49 offen sc1
    buffer_load_dwordx4 v50, s[28:31], s48 offen lds
    v_mfma_f32_32x32x16_bf16 v[80:95], v[34:37], v[6:9], v[80:95]
    buffer_load_dwordx4 v[30:33], v53, s[36:39], s49 offen sc1
    buffer_load_dwordx4 v51, s[28:31], s48 offen offset:1024 lds
    s_add_u32 s48, s48, 229376
    s_add_u32 s49, s49, 57344
    v_mfma_f32_32x32x16_bf16 v[112:127], v[38:41], v[6:9], v[112:127]
    s_waitcnt vmcnt(8)
    ds_read_b64_tr_b16 v[42:43], v54 offset:2048
    ds_read_b64_tr_b16 v[44:45], v54 offset:2560
    ds_read_b64_tr_b16 v[46:47], v55 offset:2048
    ds_read_b64_tr_b16 v[48:49], v55 offset:2560
    v_mfma_f32_32x32x16_bf16 v[96:111], v[38:41], v[2:5], v[96:111]
    s_waitcnt lgkmcnt(0)
    v_mfma_f32_32x32x16_bf16 v[64:79], v[42:45], v[10:13], v[64:79]
    s_add_u32 m0, s27, 0
    buffer_load_dwordx4 v[2:5], v52, s[36:39], s49 offen sc1
    buffer_load_dwordx4 v50, s[28:31], s48 offen lds
    v_mfma_f32_32x32x16_bf16 v[80:95], v[42:45], v[14:17], v[80:95]
    buffer_load_dwordx4 v[6:9], v53, s[36:39], s49 offen sc1
    buffer_load_dwordx4 v51, s[28:31], s48 offen offset:1024 lds
    s_add_u32 s48, s48, 229376
    s_add_u32 s49, s49, 57344
    v_mfma_f32_32x32x16_bf16 v[112:127], v[46:49], v[14:17], v[112:127]
    s_waitcnt vmcnt(8)
    ds_read_b64_tr_b16 v[34:35], v54 offset:4096
    ds_read_b64_tr_b16 v[36:37], v54 offset:4608
    ds_read_b64_tr_b16 v[38:39], v55 offset:4096
    ds_read_b64_tr_b16 v[40:41], v55 offset:4608
    v_mfma_f32_32x32x16_bf16 v[96:111], v[46:49], v[10:13], v[96:111]
    s_waitcnt lgkmcnt(0)
    v_mfma_f32_32x32x16_bf16 v[64:79], v[34:37], v[18:21], v[64:79]
    s_add_u32 m0, s27, 2048
    buffer_load_dwordx4 v[10:13], v52, s[36:39], s49 offen sc1
    buffer_load_dwordx4 v50, s[28:31], s48 offen lds
    v_mfma_f32_32x32x16_bf16 v[80:95], v[34:37], v[22:25], v[80:95]
    buffer_load_dwordx4 v[14:17], v53, s[36:39], s49 offen sc1
    buffer_load_dwordx4 v51, s[28:31], s48 offen offset:1024 lds
    s_add_u32 s48, s48, 229376
    s_add_u32 s49, s49, 57344
    v_mfma_f32_32x32x16_bf16 v[112:127], v[38:41], v[22:25], v[112:127]
    s_waitcnt vmcnt(8)
    ds_read_b64_tr_b16 v[42:43], v54 offset:6144
    ds_read_b64_tr_b16 v[44:45], v54 offset:6656
    ds_read_b64_tr_b16 v[46:47], v55 offset:6144
    ds_read_b64_tr_b16 v[48:49], v55 offset:6656
    v_mfma_f32_32x32x16_bf16 v[96:111], v[38:41], v[18:21], v[96:111]
    s_waitcnt lgkmcnt(0)
    v_mfma_f32_32x32x16_bf16 v[64:79], v[42:45], v[26:29], v[64:79]
    s_add_u32 m0, s27, 4096
    buffer_load_dwordx4 v[18:21], v52, s[36:39], s49 offen sc1
    buffer_load_dwordx4 v50, s[28:31], s48 offen lds
    v_mfma_f32_32x32x16_bf16 v[80:95], v[42:45], v[30:33], v[80:95]
    buffer_load_dwordx4 v[22:25], v53, s[36:39], s49 offen sc1
    buffer_load_dwordx4 v51, s[28:31], s48 offen offset:1024 lds
    s_add_u32 s48, s48, 229376
    s_add_u32 s49, s49, 57344
    v_mfma_f32_32x32x16_bf16 v[112:127], v[46:49], v[30:33], v[112:127]
    s_waitcnt vmcnt(8)
    ds_read_b64_tr_b16 v[34:35], v54 offset:0
    ds_read_b64_tr_b16 v[36:37], v54 offset:512
    ds_read_b64_tr_b16 v[38:39], v55 offset:0
    ds_read_b64_tr_b16 v[40:41], v55 offset:512
    v_mfma_f32_32x32x16_bf16 v[96:111], v[46:49], v[26:29], v[96:111]
    s_waitcnt lgkmcnt(0)
    v_mfma_f32_32x32x16_bf16 v[64:79], v[34:37], v[2:5], v[64:79]
    s_add_u32 m0, s27, 6144
    buffer_load_dwordx4 v[26:29], v52, s[36:39], s49 offen sc1
    buffer_load_dwordx4 v50, s[28:31], s48 offen lds
    v_mfma_f32_32x32x16_bf16 v[80:95], v[34:37], v[6:9], v[80:95]
    buffer_load_dwordx4 v[30:33], v53, s[36:39], s49 offen sc1
    buffer_load_dwordx4 v51, s[28:31], s48 offen offset:1024 lds
    s_add_u32 s48, s48, 229376
    s_add_u32 s49, s49, 57344
    v_mfma_f32_32x32x16_bf16 v[112:127], v[38:41], v[6:9], v[112:127]
    s_waitcnt vmcnt(8)
    ds_read_b64_tr_b16 v[42:43], v54 offset:2048
    ds_read_b64_tr_b16 v[44:45], v54 offset:2560
    ds_read_b64_tr_b16 v[46:47], v55 offset:2048
    ds_read_b64_tr_b16 v[48:49], v55 offset:2560
    v_mfma_f32_32x32x16_bf16 v[96:111], v[38:41], v[2:5], v[96:111]
    s_waitcnt lgkmcnt(0)
    v_mfma_f32_32x32x16_bf16 v[64:79], v[42:45], v[10:13], v[64:79]
    s_add_u32 m0, s27, 0
    buffer_load_dwordx4 v[2:5], v52, s[36:39], s49 offen sc1
    buffer_load_dwordx4 v50, s[28:31], s48 offen lds
    v_mfma_f32_32x32x16_bf16 v[80:95], v[42:45], v[14:17], v[80:95]
    buffer_load_dwordx4 v[6:9], v53, s[36:39], s49 offen sc1
    buffer_load_dwordx4 v51, s[28:31], s48 offen offset:1024 lds
    s_add_u32 s48, s48, 229376
    s_add_u32 s49, s49, 57344
    v_mfma_f32_32x32x16_bf16 v[112:127], v[46:49], v[14:17], v[112:127]
    s_waitcnt vmcnt(8)
    ds_read_b64_tr_b16 v[34:35], v54 offset:4096
    ds_read_b64_tr_b16 v[36:37], v54 offset:4608
    ds_read_b64_tr_b16 v[38:39], v55 offset:4096
    ds_read_b64_tr_b16 v[40:41], v55 offset:4608
    v_mfma_f32_32x32x16_bf16 v[96:111], v[46:49], v[10:13], v[96:111]
    s_waitcnt lgkmcnt(0)
    v_mfma_f32_32x32x16_bf16 v[64:79], v[34:37], v[18:21], v[64:79]
    s_add_u32 m0, s27, 2048
    buffer_load_dwordx4 v[10:13], v52, s[36:39], s49 offen sc1
    buffer_load_dwordx4 v50, s[28:31], s48 offen lds
    v_mfma_f32_32x32x16_bf16 v[80:95], v[34:37], v[22:25], v[80:95]
    buffer_load_dwordx4 v[14:17], v53, s[36:39], s49 offen sc1
    buffer_load_dwordx4 v51, s[28:31], s48 offen offset:1024 lds
    s_add_u32 s48, s48, 229376
    s_add_u32 s49, s49, 57344
    v_mfma_f32_32x32x16_bf16 v[112:127], v[38:41], v[22:25], v[112:127]
    s_waitcnt vmcnt(8)
    ds_read_b64_tr_b16 v[42:43], v54 offset:6144
    ds_read_b64_tr_b16 v[44:45], v54 offset:6656
    ds_read_b64_tr_b16 v[46:47], v55 offset:6144
    ds_read_b64_tr_b16 v[48:49], v55 offset:6656
    v_mfma_f32_32x32x16_bf16 v[96:111], v[38:41], v[18:21], v[96:111]
    s_waitcnt lgkmcnt(0)
    v_mfma_f32_32x32x16_bf16 v[64:79], v[42:45], v[26:29], v[64:79]
    s_add_u32 m0, s27, 4096
    buffer_load_dwordx4 v[18:21], v52, s[36:39], s49 offen sc1
    buffer_load_dwordx4 v50, s[28:31], s48 offen lds
    v_mfma_f32_32x32x16_bf16 v[80:95], v[42:45], v[30:33], v[80:95]
    buffer_load_dwordx4 v[22:25], v53, s[36:39], s49 offen sc1
    buffer_load_dwordx4 v51, s[28:31], s48 offen offset:1024 lds
    s_add_u32 s48, s48, 229376
    s_add_u32 s49, s49, 57344
    v_mfma_f32_32x32x16_bf16 v[112:127], v[46:49], v[30:33], v[112:127]
    s_waitcnt vmcnt(8)
    ds_read_b64_tr_b16 v[34:35], v54 offset:0
    ds_read_b64_tr_b16 v[36:37], v54 offset:512
    ds_read_b64_tr_b16 v[38:39], v55 offset:0
    ds_read_b64_tr_b16 v[40:41], v55 offset:512
    v_mfma_f32_32x32x16_bf16 v[96:111], v[46:49], v[26:29], v[96:111]
    s_waitcnt lgkmcnt(0)
    v_mfma_f32_32x32x16_bf16 v[64:79], v[34:37], v[2:5], v[64:79]
    s_add_u32 m0, s27, 6144
    buffer_load_dwordx4 v[26:29], v52, s[36:39], s49 offen sc1
    buffer_load_dwordx4 v50, s[28:31], s48 offen lds
    v_mfma_f32_32x32x16_bf16 v[80:95], v[34:37], v[6:9], v[80:95]
    buffer_load_dwordx4 v[30:33], v53, s[36:39], s49 offen sc1
    buffer_load_dwordx4 v51, s[28:31], s48 offen offset:1024 lds
    s_add_u32 s48, s48, 229376
    s_add_u32 s49, s49, 57344
    v_mfma_f32_32x32x16_bf16 v[112:127], v[38:41], v[6:9], v[112:127]
    s_waitcnt vmcnt(8)
    ds_read_b64_tr_b16 v[42:43], v54 offset:2048
    ds_read_b64_tr_b16 v[44:45], v54 offset:2560
    ds_read_b64_tr_b16 v[46:47], v55 offset:2048
    ds_read_b64_tr_b16 v[48:49], v55 offset:2560
    v_mfma_f32_32x32x16_bf16 v[96:111], v[38:41], v[2:5], v[96:111]
    s_barrier
    s_waitcnt lgkmcnt(0)
    v_mfma_f32_32x32x16_bf16 v[64:79], v[42:45], v[10:13], v[64:79]
    v_mfma_f32_32x32x16_bf16 v[80:95], v[42:45], v[14:17], v[80:95]
    v_mfma_f32_32x32x16_bf16 v[112:127], v[46:49], v[14:17], v[112:127]
    s_waitcnt vmcnt(4)
    ds_read_b64_tr_b16 v[34:35], v54 offset:4096
    ds_read_b64_tr_b16 v[36:37], v54 offset:4608
    ds_read_b64_tr_b16 v[38:39], v55 offset:4096
    ds_read_b64_tr_b16 v[40:41], v55 offset:4608
    v_mfma_f32_32x32x16_bf16 v[96:111], v[46:49], v[10:13], v[96:111]
    s_waitcnt lgkmcnt(0)
    v_mfma_f32_32x32x16_bf16 v[64:79], v[34:37], v[18:21], v[64:79]
    v_mfma_f32_32x32x16_bf16 v[80:95], v[34:37], v[22:25], v[80:95]
    v_mfma_f32_32x32x16_bf16 v[112:127], v[38:41], v[22:25], v[112:127]
    s_waitcnt vmcnt(0)
    ds_read_b64_tr_b16 v[42:43], v54 offset:6144
    ds_read_b64_tr_b16 v[44:45], v54 offset:6656
    ds_read_b64_tr_b16 v[46:47], v55 offset:6144
    ds_read_b64_tr_b16 v[48:49], v55 offset:6656
    v_mfma_f32_32x32x16_bf16 v[96:111], v[38:41], v[18:21], v[96:111]
    s_waitcnt lgkmcnt(0)
    v_mfma_f32_32x32x16_bf16 v[64:79], v[42:45], v[26:29], v[64:79]
    v_mfma_f32_32x32x16_bf16 v[80:95], v[42:45], v[30:33], v[80:95]
    v_mfma_f32_32x32x16_bf16 v[112:127], v[46:49], v[30:33], v[112:127]
    v_mfma_f32_32x32x16_bf16 v[96:111], v[46:49], v[26:29], v[96:111]
    s_setprio 2
    v_lshlrev_b32 v16, 4, v1
    v_add_u32 v16, 32768, v16
    s_mul_i32 s53, s26, 12288
    v_add_u32 v17, s53, v16
    s_cmp_eq_u32 s26, 1
    s_cbranch_scc1 g1_r1
    s_cmp_eq_u32 s26, 2
    s_cbranch_scc1 g1_r2
    s_cmp_eq_u32 s26, 3
    s_cbranch_scc1 g1_r3
    s_nop 7
    ds_write_b128 v16, v[80:83] offset:20480
    ds_write_b128 v16, v[84:87] offset:21504
    ds_write_b128 v16, v[88:91] offset:22528
    ds_write_b128 v16, v[92:95] offset:23552
    ds_write_b128 v16, v[96:99] offset:28672
    ds_write_b128 v16, v[100:103] offset:29696
    ds_write_b128 v16, v[104:107] offset:30720
    ds_write_b128 v16, v[108:111] offset:31744
    ds_write_b128 v16, v[112:115] offset:36864
    ds_write_b128 v16, v[116:119] offset:37888
    ds_write_b128 v16, v[120:123] offset:38912
    ds_write_b128 v16, v[124:127] offset:39936
    v_lshlrev_b32 v18, 16, v56
    v_and_b32 v19, 0xffff0000, v56
    v_lshlrev_b32 v20, 16, v57
    v_and_b32 v21, 0xffff0000, v57
    v_lshlrev_b32 v22, 16, v58
    v_and_b32 v23, 0xffff0000, v58
    v_lshlrev_b32 v24, 16, v59
    v_and_b32 v25, 0xffff0000, v59
    v_lshlrev_b32 v26, 16, v60
    v_and_b32 v27, 0xffff0000, v60
    v_lshlrev_b32 v28, 16, v61
    v_and_b32 v29, 0xffff0000, v61
    v_lshlrev_b32 v30, 16, v62
    v_and_b32 v31, 0xffff0000, v62
    v_lshlrev_b32 v32, 16, v63
    v_and_b32 v33, 0xffff0000, v63
    v_pk_add_f32 v[18:19], v[18:19], v[64:65]
    v_pk_add_f32 v[20:21], v[20:21], v[66:67]
    v_pk_add_f32 v[22:23], v[22:23], v[68:69]
    v_pk_add_f32 v[24:25], v[24:25], v[70:71]
    v_pk_add_f32 v[26:27], v[26:27], v[72:73]
    v_pk_add_f32 v[28:29], v[28:29], v[74:75]
    v_pk_add_f32 v[30:31], v[30:31], v[76:77]
    v_pk_add_f32 v[32:33], v[32:33], v[78:79]
    s_branch g1_rj
g1_r1:
    s_nop 7
    ds_write_b128 v16, v[64:67] offset:0
    ds_write_b128 v16, v[68:71] offset:1024
    ds_write_b128 v16, v[72:75] offset:2048
    ds_write_b128 v16, v[76:79] offset:3072
    ds_write_b128 v16, v[96:99] offset:32768
    ds_write_b128 v16, v[100:103] offset:33792
    ds_write_b128 v16, v[104:107] offset:34816
    ds_write_b128 v16, v[108:111] offset:35840
    ds_write_b128 v16, v[112:115] offset:40960
    ds_write_b128 v16, v[116:119] offset:41984
    ds_write_b128 v16, v[120:123] offset:43008
    ds_write_b128 v16, v[124:127] offset:44032
    v_lshlrev_b32 v18, 16, v56
    v_and_b32 v19, 0xffff0000, v56
    v_lshlrev_b32 v20, 16, v57
    v_and_b32 v21, 0xffff0000, v57
    v_lshlrev_b32 v22, 16, v58
    v_and_b32 v23, 0xffff0000, v58
    v_lshlrev_b32 v24, 16, v59
    v_and_b32 v25, 0xffff0000, v59
    v_lshlrev_b32 v26, 16, v60
    v_and_b32 v27, 0xffff0000, v60
    v_lshlrev_b32 v28, 16, v61
    v_and_b32 v29, 0xffff0000, v61
    v_lshlrev_b32 v30, 16, v62
    v_and_b32 v31, 0xffff0000, v62
    v_lshlrev_b32 v32, 16, v63
    v_and_b32 v33, 0xffff0000, v63
    v_pk_add_f32 v[18:19], v[18:19], v[80:81]
    v_pk_add_f32 v[20:21], v[20:21], v[82:83]
    v_pk_add_f32 v[22:23], v[22:23], v[84:85]
    v_pk_add_f32 v[24:25], v[24:25], v[86:87]
    v_pk_add_f32 v[26:27], v[26:27], v[88:89]
    v_pk_add_f32 v[28:29], v[28:29], v[90:91]
    v_pk_add_f32 v[30:31], v[30:31], v[92:93]
    v_pk_add_f32 v[32:33], v[32:33], v[94:95]
    s_branch g1_rj
g1_r2:
    s_nop 7
    ds_write_b128 v16, v[64:67] offset:4096
    ds_write_b128 v16, v[68:71] offset:5120
    ds_write_b128 v16, v[72:75] offset:6144
    ds_write_b128 v16, v[76:79] offset:7168
    ds_write_b128 v16, v[80:83] offset:12288
    ds_write_b128 v16, v[84:87] offset:13312
    ds_write_b128 v16, v[88:91] offset:14336
    ds_write_b128 v16, v[92:95] offset:15360
    ds_write_b128 v16, v[112:115] offset:45056
    ds_write_b128 v16, v[116:119] offset:46080
    ds_write_b128 v16, v[120:123] offset:47104
    ds_write_b128 v16, v[124:127] offset:48128
    v_lshlrev_b32 v18, 16, v56
    v_and_b32 v19, 0xffff0000, v56
    v_lshlrev_b32 v20, 16, v57
    v_and_b32 v21, 0xffff0000, v57
    v_lshlrev_b32 v22, 16, v58
    v_and_b32 v23, 0xffff0000, v58
    v_lshlrev_b32 v24, 16, v59
    v_and_b32 v25, 0xffff0000, v59
    v_lshlrev_b32 v26, 16, v60
    v_and_b32 v27, 0xffff0000, v60
    v_lshlrev_b32 v28, 16, v61
    v_and_b32 v29, 0xffff0000, v61
    v_lshlrev_b32 v30, 16, v62
    v_and_b32 v31, 0xffff0000, v62
    v_lshlrev_b32 v32, 16, v63
    v_and_b32 v33, 0xffff0000, v63
    v_pk_add_f32 v[18:19], v[18:19], v[96:97]
    v_pk_add_f32 v[20:21], v[20:21], v[98:99]
    v_pk_add_f32 v[22:23], v[22:23], v[100:101]
    v_pk_add_f32 v[24:25], v[24:25], v[102:103]
    v_pk_add_f32 v[26:27], v[26:27], v[104:105]
    v_pk_add_f32 v[28:29], v[28:29], v[106:107]
    v_pk_add_f32 v[30:31], v[30:31], v[108:109]
    v_pk_add_f32 v[32:33], v[32:33], v[110:111]
    s_branch g1_rj
g1_r3:
    s_nop 7
    ds_write_b128 v16, v[64:67] offset:8192
    ds_write_b128 v16, v[68:71] offset:9216
    ds_write_b128 v16, v[72:75] offset:10240
    ds_write_b128 v16, v[76:79] offset:11264
    ds_write_b128 v16, v[80:83] offset:16384
    ds_write_b128 v16, v[84:87] offset:17408
    ds_write_b128 v16, v[88:91] offset:18432
    ds_write_b128 v16, v[92:95] offset:19456
    ds_write_b128 v16, v[96:99] offset:24576
    ds_write_b128 v16, v[100:103] offset:25600
    ds_write_b128 v16, v[104:107] offset:26624
    ds_write_b128 v16, v[108:111] offset:27648
    v_lshlrev_b32 v18, 16, v56
    v_and_b32 v19, 0xffff0000, v56
    v_lshlrev_b32 v20, 16, v57
    v_and_b32 v21, 0xffff0000, v57
    v_lshlrev_b32 v22, 16, v58
    v_and_b32 v23, 0xffff0000, v58
    v_lshlrev_b32 v24, 16, v59
    v_and_b32 v25, 0xffff0000, v59
    v_lshlrev_b32 v26, 16, v60
    v_and_b32 v27, 0xffff0000, v60
    v_lshlrev_b32 v28, 16, v61
    v_and_b32 v29, 0xffff0000, v61
    v_lshlrev_b32 v30, 16, v62
    v_and_b32 v31, 0xffff0000, v62
    v_lshlrev_b32 v32, 16, v63
    v_and_b32 v33, 0xffff0000, v63
    v_pk_add_f32 v[18:19], v[18:19], v[112:113]
    v_pk_add_f32 v[20:21], v[20:21], v[114:115]
    v_pk_add_f32 v[22:23], v[22:23], v[116:117]
    v_pk_add_f32 v[24:25], v[24:25], v[118:119]
    v_pk_add_f32 v[26:27], v[26:27], v[120:121]
    v_pk_add_f32 v[28:29], v[28:29], v[122:123]
    v_pk_add_f32 v[30:31], v[30:31], v[124:125]
    v_pk_add_f32 v[32:33], v[32:33], v[126:127]
g1_rj:
    s_waitcnt lgkmcnt(0)
    s_barrier
    ds_read_b128 v[64:67], v17 offset:0
    ds_read_b128 v[68:71], v17 offset:1024
    ds_read_b128 v[72:75], v17 offset:2048
    ds_read_b128 v[76:79], v17 offset:3072
    ds_read_b128 v[80:83], v17 offset:4096
    ds_read_b128 v[84:87], v17 offset:5120
    ds_read_b128 v[88:91], v17 offset:6144
    ds_read_b128 v[92:95], v17 offset:7168
    ds_read_b128 v[96:99], v17 offset:8192
    ds_read_b128 v[100:103], v17 offset:9216
    ds_read_b128 v[104:107], v17 offset:10240
    ds_read_b128 v[108:111], v17 offset:11264
    s_waitcnt lgkmcnt(8)
    v_pk_add_f32 v[18:19], v[18:19], v[64:65]
    v_pk_add_f32 v[20:21], v[20:21], v[66:67]
    v_pk_add_f32 v[22:23], v[22:23], v[68:69]
    v_pk_add_f32 v[24:25], v[24:25], v[70:71]
    v_pk_add_f32 v[26:27], v[26:27], v[72:73]
    v_pk_add_f32 v[28:29], v[28:29], v[74:75]
    v_pk_add_f32 v[30:31], v[30:31], v[76:77]
    v_pk_add_f32 v[32:33], v[32:33], v[78:79]
    s_waitcnt lgkmcnt(4)
    v_pk_add_f32 v[18:19], v[18:19], v[80:81]
    v_pk_add_f32 v[20:21], v[20:21], v[82:83]
    v_pk_add_f32 v[22:23], v[22:23], v[84:85]
    v_pk_add_f32 v[24:25], v[24:25], v[86:87]
    v_pk_add_f32 v[26:27], v[26:27], v[88:89]
    v_pk_add_f32 v[28:29], v[28:29], v[90:91]
    v_pk_add_f32 v[30:31], v[30:31], v[92:93]
    v_pk_add_f32 v[32:33], v[32:33], v[94:95]
    s_waitcnt lgkmcnt(0)
    v_pk_add_f32 v[18:19], v[18:19], v[96:97]
    v_pk_add_f32 v[20:21], v[20:21], v[98:99]
    v_pk_add_f32 v[22:23], v[22:23], v[100:101]
    v_pk_add_f32 v[24:25], v[24:25], v[102:103]
    v_pk_add_f32 v[26:27], v[26:27], v[104:105]
    v_pk_add_f32 v[28:29], v[28:29], v[106:107]
    v_pk_add_f32 v[30:31], v[30:31], v[108:109]
    v_pk_add_f32 v[32:33], v[32:33], v[110:111]
    s_mul_i32 s55, s55, 28672
    s_lshl_b32 s53, s51, 10
    s_add_u32 s55, s55, s53
    s_add_u32 s55, s55, 8388608
    s_add_u32 s54, s55, 14336
    s_and_b32 s53, s26, 1
    s_lshl_b32 s53, s53, 9
    v_add_u32 v53, s53, v52
    v_mov_b32 v34, 0xc0135761
    v_mov_b32 v35, v34
    v_mov_b32 v36, 0xbdd2d3e8
    v_mov_b32 v37, v36
    v_mov_b32 v38, 1.0
    v_mov_b32 v39, 1.0
    v_pk_mul_f32 v[64:65], v[18:19], v[18:19]
    v_pk_mul_f32 v[66:67], v[20:21], v[20:21]
    v_pk_mul_f32 v[68:69], v[22:23], v[22:23]
    v_pk_mul_f32 v[70:71], v[24:25], v[24:25]
    v_pk_mul_f32 v[72:73], v[26:27], v[26:27]
    v_pk_mul_f32 v[74:75], v[28:29], v[28:29]
    v_pk_mul_f32 v[76:77], v[30:31], v[30:31]
    v_pk_mul_f32 v[78:79], v[32:33], v[32:33]
    v_pk_fma_f32 v[64:65], v[64:65], v[36:37], v[34:35]
    v_pk_fma_f32 v[66:67], v[66:67], v[36:37], v[34:35]
    v_pk_fma_f32 v[68:69], v[68:69], v[36:37], v[34:35]
    v_pk_fma_f32 v[70:71], v[70:71], v[36:37], v[34:35]
    v_pk_fma_f32 v[72:73], v[72:73], v[36:37], v[34:35]
    v_pk_fma_f32 v[74:75], v[74:75], v[36:37], v[34:35]
    v_pk_fma_f32 v[76:77], v[76:77], v[36:37], v[34:35]
    v_pk_fma_f32 v[78:79], v[78:79], v[36:37], v[34:35]
    v_pk_mul_f32 v[64:65], v[64:65], v[18:19]
    v_pk_mul_f32 v[66:67], v[66:67], v[20:21]
    v_pk_mul_f32 v[68:69], v[68:69], v[22:23]
    v_pk_mul_f32 v[70:71], v[70:71], v[24:25]
    v_pk_mul_f32 v[72:73], v[72:73], v[26:27]
    v_pk_mul_f32 v[74:75], v[74:75], v[28:29]
    v_pk_mul_f32 v[76:77], v[76:77], v[30:31]
    v_pk_mul_f32 v[78:79], v[78:79], v[32:33]
    v_exp_f32 v64, v64
    v_exp_f32 v65, v65
    v_exp_f32 v66, v66
    v_exp_f32 v67, v67
    v_exp_f32 v68, v68
    v_exp_f32 v69, v69
    v_exp_f32 v70, v70
    v_exp_f32 v71, v71
    v_exp_f32 v72, v72
    v_exp_f32 v73, v73
    v_exp_f32 v74, v74
    v_exp_f32 v75, v75
    v_exp_f32 v76, v76
    v_exp_f32 v77, v77
    v_exp_f32 v78, v78
    v_exp_f32 v79, v79
    v_pk_add_f32 v[64:65], v[64:65], v[38:39]
    v_pk_add_f32 v[66:67], v[66:67], v[38:39]
    v_pk_add_f32 v[68:69], v[68:69], v[38:39]
    v_pk_add_f32 v[70:71], v[70:71], v[38:39]
    v_pk_add_f32 v[72:73], v[72:73], v[38:39]
    v_pk_add_f32 v[74:75], v[74:75], v[38:39]
    v_pk_add_f32 v[76:77], v[76:77], v[38:39]
    v_pk_add_f32 v[78:79], v[78:79], v[38:39]
    v_rcp_f32 v64, v64
    v_rcp_f32 v65, v65
    v_rcp_f32 v66, v66
    v_rcp_f32 v67, v67
    v_rcp_f32 v68, v68
    v_rcp_f32 v69, v69
    v_rcp_f32 v70, v70
    v_rcp_f32 v71, v71
    v_rcp_f32 v72, v72
    v_rcp_f32 v73, v73
    v_rcp_f32 v74, v74
    v_rcp_f32 v75, v75
    v_rcp_f32 v76, v76
    v_rcp_f32 v77, v77
    v_rcp_f32 v78, v78
    v_rcp_f32 v79, v79
    v_pk_mul_f32 v[64:65], v[64:65], v[18:19]
    v_pk_mul_f32 v[66:67], v[66:67], v[20:21]
    v_pk_mul_f32 v[68:69], v[68:69], v[22:23]
    v_pk_mul_f32 v[70:71], v[70:71], v[24:25]
    v_pk_mul_f32 v[72:73], v[72:73], v[26:27]
    v_pk_mul_f32 v[74:75], v[74:75], v[28:29]
    v_pk_mul_f32 v[76:77], v[76:77], v[30:31]
    v_pk_mul_f32 v[78:79], v[78:79], v[32:33]
    v_cvt_pk_bf16_f32 v2, v64, v65
    v_cvt_pk_bf16_f32 v3, v66, v67
    v_cvt_pk_bf16_f32 v4, v68, v69
    v_cvt_pk_bf16_f32 v5, v70, v71
    v_cvt_pk_bf16_f32 v6, v72, v73
    v_cvt_pk_bf16_f32 v7, v74, v75
    v_cvt_pk_bf16_f32 v8, v76, v77
    v_cvt_pk_bf16_f32 v9, v78, v79
    buffer_store_dwordx4 v[2:5], v53, s[36:39], s55 offen sc1
    buffer_store_dwordx4 v[6:9], v53, s[36:39], s54 offen sc1
    s_waitcnt vmcnt(0)
    s_barrier
b_fin:
    s_lshr_b32 s54, s2, 3
    s_and_b32 s53, s2, 1
    s_mul_i32 s53, s53, 28
    s_add_u32 s53, s53, s54
    s_lshr_b32 s51, s53, 3
    s_and_b32 s53, s53, 7
    s_bfe_u32 s50, s2, 0x20001
    s_lshl_b32 s50, s50, 3
    s_add_u32 s50, s50, s53
    s_cmp_ge_u32 s54, 28
    s_cbranch_scc1 b_exit
    s_lshl_b32 s27, s26, 13
    s_mul_i32 s48, s26, 65536
    s_lshl_b32 s53, s50, 7
    s_add_u32 s48, s48, s53
    s_mul_i32 s49, s26, 14336
    s_lshl_b32 s53, s51, 10
    s_add_u32 s49, s49, s53
    s_add_u32 s49, s49, 8388608
    v_lshrrev_b32 v62, 3, v1
    v_and_b32 v63, 7, v1
    v_bfe_u32 v50, v1, 4, 1
    v_lshlrev_b32 v50, 2, v50
    v_xor_b32 v63, v63, v50
    v_mul_u32_u24 v62, 4096, v62
    v_lshl_add_u32 v50, v63, 4, v62
    v_add_u32 v51, 31744, v50
    v_lshrrev_b32 v62, 5, v1
    v_mul_u32_u24 v62, 4, v62
    v_bfe_u32 v63, v1, 2, 2
    v_add_u32 v62, v62, v63
    v_lshlrev_b32 v62, 7, v62
    v_bfe_u32 v63, v1, 3, 1
    v_lshl_add_u32 v62, v63, 6, v62
    v_bfe_u32 v63, v1, 4, 1
    v_lshl_add_u32 v62, v63, 5, v62
    v_and_b32 v63, 3, v1
    v_lshl_add_u32 v62, v63, 3, v62
    v_add_u32 v54, s27, v62
    v_xor_b32 v55, 64, v54
    v_lshrrev_b32 v62, 5, v1
    v_mul_u32_u24 v62, 7168, v62
    v_and_b32 v63, 31, v1
    v_lshl_add_u32 v52, v63, 4, v62
    v_add_u32 v53, 512, v52
    s_waitcnt lgkmcnt(0)
    s_mov_b32 s28, s16
    s_mov_b32 s29, s17
    s_mov_b32 s30, 7340032
    s_mov_b32 s31, 0x20000
    s_mov_b32 s32, s8
    s_mov_b32 s33, s9
    s_mov_b32 s34, 401408
    s_mov_b32 s35, 0x20000
    s_mov_b32 s36, s24
    s_mov_b32 s37, s25
    s_mov_b32 s38, 16777216
    s_mov_b32 s39, 0x20000
    s_mov_b32 s40, s4
    s_mov_b32 s41, s5
    s_mov_b32 s42, 1835008
    s_mov_b32 s43, 0x20000
    s_mov_b32 s44, s18
    s_mov_b32 s45, s19
    s_mov_b32 s46, 4096
    s_mov_b32 s47, 0x20000
    s_and_b32 s53, s26, 1
    s_lshl_b32 s54, s50, 1
    s_add_u32 s53, s53, s54
    s_lshl_b32 s59, s53, 6
    s_mul_i32 s60, s53, 28672
    s_lshl_b32 s58, s53, 9
    s_lshl_b32 s53, s51, 7
    s_add_u32 s60, s60, s53
    s_lshr_b32 s55, s26, 1
    s_lshl_b32 s54, s55, 6
    s_add_u32 s60, s60, s54
    s_lshl_b32 s54, s55, 20
    s_add_u32 s58, s58, s54
    s_add_u32 s58, s58, 10485760
    v_and_b32 v2, 31, v1
    v_lshrrev_b32 v3, 5, v1
    v_lshlrev_b32 v4, 1, v2
    v_mul_u32_u24 v2, 896, v2
    v_lshl_add_u32 v2, v3, 3, v2
    buffer_load_dwordx2 v[56:57], v2, s[40:43], s60 offen offset:0
    buffer_load_dwordx2 v[58:59], v2, s[40:43], s60 offen offset:16
    buffer_load_dwordx2 v[60:61], v2, s[40:43], s60 offen offset:32
    buffer_load_dwordx2 v[62:63], v2, s[40:43], s60 offen offset:48
    buffer_load_ushort v0, v4, s[44:47], s59 offen
    s_setprio 0
    s_barrier
    s_add_u32 m0, s27, 0
    buffer_load_dwordx4 v[2:5], v52, s[36:39], s49 offen sc1
    buffer_load_dwordx4 v50, s[28:31], s48 offen lds
    buffer_load_dwordx4 v[6:9], v53, s[36:39], s49 offen sc1
    buffer_load_dwordx4 v51, s[28:31], s48 offen offset:1024 lds
    s_add_u32 s48, s48, 262144
    s_add_u32 s49, s49, 57344
    s_add_u32 m0, s27, 2048
    buffer_load_dwordx4 v[10:13], v52, s[36:39], s49 offen sc1
    buffer_load_dwordx4 v50, s[28:31], s48 offen lds
    buffer_load_dwordx4 v[14:17], v53, s[36:39], s49 offen sc1
    buffer_load_dwordx4 v51, s[28:31], s48 offen offset:1024 lds
    s_add_u32 s48, s48, 262144
    s_add_u32 s49, s49, 57344
    s_add_u32 m0, s27, 4096
    buffer_load_dwordx4 v[18:21], v52, s[36:39], s49 offen sc1
    buffer_load_dwordx4 v50, s[28:31], s48 offen lds
    buffer_load_dwordx4 v[22:25], v53, s[36:39], s49 offen sc1
    buffer_load_dwordx4 v51, s[28:31], s48 offen offset:1024 lds
    s_add_u32 s48, s48, 262144
    s_add_u32 s49, s49, 57344
    s_waitcnt vmcnt(8)
    ds_read_b64_tr_b16 v[34:35], v54 offset:0
    ds_read_b64_tr_b16 v[36:37], v54 offset:1024
    ds_read_b64_tr_b16 v[38:39], v55 offset:0
    ds_read_b64_tr_b16 v[40:41], v55 offset:1024
    s_waitcnt lgkmcnt(0)
    v_mfma_f32_32x32x16_bf16 v[64:79], v[2:5], v[34:37], 0
    s_add_u32 m0, s27, 6144
    buffer_load_dwordx4 v[26:29], v52, s[36:39], s49 offen sc1
    buffer_load_dwordx4 v50, s[28:31], s48 offen lds
    v_mfma_f32_32x32x16_bf16 v[96:111], v[6:9], v[34:37], 0
    buffer_load_dwordx4 v[30:33], v53, s[36:39], s49 offen sc1
    buffer_load_dwordx4 v51, s[28:31], s48 offen offset:1024 lds
    s_add_u32 s48, s48, 262144
    s_add_u32 s49, s49, 57344
    v_mfma_f32_32x32x16_bf16 v[112:127], v[6:9], v[38:41], 0
    s_waitcnt vmcnt(6)
    ds_read_b64_tr_b16 v[42:43], v54 offset:2048
    ds_read_b64_tr_b16 v[44:45], v54 offset:3072
    ds_read_b64_tr_b16 v[46:47], v55 offset:2048
    ds_read_b64_tr_b16 v[48:49], v55 offset:3072
    v_mfma_f32_32x32x16_bf16 v[80:95], v[2:5], v[38:41], 0
    s_waitcnt lgkmcnt(0)
    v_mfma_f32_32x32x16_bf16 v[64:79], v[10:13], v[42:45], v[64:79]
    s_add_u32 m0, s27, 0
    buffer_load_dwordx4 v[2:5], v52, s[36:39], s49 offen sc1
    buffer_load_dwordx4 v50, s[28:31], s48 offen lds
    v_mfma_f32_32x32x16_bf16 v[96:111], v[14:17], v[42:45], v[96:111]
    buffer_load_dwordx4 v[6:9], v53, s[36:39], s49 offen sc1
    buffer_load_dwordx4 v51, s[28:31], s48 offen offset:1024 lds
    s_add_u32 s48, s48, 262144
    s_add_u32 s49, s49, 57344
    v_mfma_f32_32x32x16_bf16 v[112:127], v[14:17], v[46:49], v[112:127]
    s_waitcnt vmcnt(6)
    ds_read_b64_tr_b16 v[34:35], v54 offset:4096
    ds_read_b64_tr_b16 v[36:37], v54 offset:5120
    ds_read_b64_tr_b16 v[38:39], v55 offset:4096
    ds_read_b64_tr_b16 v[40:41], v55 offset:5120
    v_mfma_f32_32x32x16_bf16 v[80:95], v[10:13], v[46:49], v[80:95]
    s_waitcnt lgkmcnt(0)
    v_mfma_f32_32x32x16_bf16 v[64:79], v[18:21], v[34:37], v[64:79]
    s_add_u32 m0, s27, 2048
    buffer_load_dwordx4 v[10:13], v52, s[36:39], s49 offen sc1
    buffer_load_dwordx4 v50, s[28:31], s48 offen lds
    v_mfma_f32_32x32x16_bf16 v[96:111], v[22:25], v[34:37], v[96:111]
    buffer_load_dwordx4 v[14:17], v53, s[36:39], s49 offen sc1
    buffer_load_dwordx4 v51, s[28:31], s48 offen offset:1024 lds
    s_add_u32 s48, s48, 262144
    s_add_u32 s49, s49, 57344
    v_mfma_f32_32x32x16_bf16 v[112:127], v[22:25], v[38:41], v[112:127]
    s_waitcnt vmcnt(6)
    ds_read_b64_tr_b16 v[42:43], v54 offset:6144
    ds_read_b64_tr_b16 v[44:45], v54 offset:7168
    ds_read_b64_tr_b16 v[46:47], v55 offset:6144
    ds_read_b64_tr_b16 v[48:49], v55 offset:7168
    v_mfma_f32_32x32x16_bf16 v[80:95], v[18:21], v[38:41], v[80:95]
    s_waitcnt lgkmcnt(0)
    v_mfma_f32_32x32x16_bf16 v[64:79], v[26:29], v[42:45], v[64:79]
    s_add_u32 m0, s27, 4096
    buffer_load_dwordx4 v[18:21], v52, s[36:39], s49 offen sc1
    buffer_load_dwordx4 v50, s[28:31], s48 offen lds
    v_mfma_f32_32x32x16_bf16 v[96:111], v[30:33], v[42:45], v[96:111]
    buffer_load_dwordx4 v[22:25], v53, s[36:39], s49 offen sc1
    buffer_load_dwordx4 v51, s[28:31], s48 offen offset:1024 lds
    s_add_u32 s48, s48, 262144
    s_add_u32 s49, s49, 57344
    v_mfma_f32_32x32x16_bf16 v[112:127], v[30:33], v[46:49], v[112:127]
    s_waitcnt vmcnt(6)
    ds_read_b64_tr_b16 v[34:35], v54 offset:0
    ds_read_b64_tr_b16 v[36:37], v54 offset:1024
    ds_read_b64_tr_b16 v[38:39], v55 offset:0
    ds_read_b64_tr_b16 v[40:41], v55 offset:1024
    v_mfma_f32_32x32x16_bf16 v[80:95], v[26:29], v[46:49], v[80:95]
    s_waitcnt lgkmcnt(0)
    v_mfma_f32_32x32x16_bf16 v[64:79], v[2:5], v[34:37], v[64:79]
    s_add_u32 m0, s27, 6144
    buffer_load_dwordx4 v[26:29], v52, s[36:39], s49 offen sc1
    buffer_load_dwordx4 v50, s[28:31], s48 offen lds
    v_mfma_f32_32x32x16_bf16 v[96:111], v[6:9], v[34:37], v[96:111]
    buffer_load_dwordx4 v[30:33], v53, s[36:39], s49 offen sc1
    buffer_load_dwordx4 v51, s[28:31], s48 offen offset:1024 lds
    s_add_u32 s48, s48, 262144
    s_add_u32 s49, s49, 57344
    v_mfma_f32_32x32x16_bf16 v[112:127], v[6:9], v[38:41], v[112:127]
    s_waitcnt vmcnt(6)
    ds_read_b64_tr_b16 v[42:43], v54 offset:2048
    ds_read_b64_tr_b16 v[44:45], v54 offset:3072
    ds_read_b64_tr_b16 v[46:47], v55 offset:2048
    ds_read_b64_tr_b16 v[48:49], v55 offset:3072
    v_mfma_f32_32x32x16_bf16 v[80:95], v[2:5], v[38:41], v[80:95]
    s_waitcnt lgkmcnt(0)
    v_mfma_f32_32x32x16_bf16 v[64:79], v[10:13], v[42:45], v[64:79]
    s_add_u32 m0, s27, 0
    buffer_load_dwordx4 v[2:5], v52, s[36:39], s49 offen sc1
    buffer_load_dwordx4 v50, s[28:31], s48 offen lds
    v_mfma_f32_32x32x16_bf16 v[96:111], v[14:17], v[42:45], v[96:111]
    buffer_load_dwordx4 v[6:9], v53, s[36:39], s49 offen sc1
    buffer_load_dwordx4 v51, s[28:31], s48 offen offset:1024 lds
    s_add_u32 s48, s48, 262144
    s_add_u32 s49, s49, 57344
    v_mfma_f32_32x32x16_bf16 v[112:127], v[14:17], v[46:49], v[112:127]
    s_waitcnt vmcnt(6)
    ds_read_b64_tr_b16 v[34:35], v54 offset:4096
    ds_read_b64_tr_b16 v[36:37], v54 offset:5120
    ds_read_b64_tr_b16 v[38:39], v55 offset:4096
    ds_read_b64_tr_b16 v[40:41], v55 offset:5120
    v_mfma_f32_32x32x16_bf16 v[80:95], v[10:13], v[46:49], v[80:95]
    s_waitcnt lgkmcnt(0)
    v_mfma_f32_32x32x16_bf16 v[64:79], v[18:21], v[34:37], v[64:79]
    s_add_u32 m0, s27, 2048
    buffer_load_dwordx4 v[10:13], v52, s[36:39], s49 offen sc1
    buffer_load_dwordx4 v50, s[28:31], s48 offen lds
    v_mfma_f32_32x32x16_bf16 v[96:111], v[22:25], v[34:37], v[96:111]
    buffer_load_dwordx4 v[14:17], v53, s[36:39], s49 offen sc1
    buffer_load_dwordx4 v51, s[28:31], s48 offen offset:1024 lds
    s_add_u32 s48, s48, 262144
    s_add_u32 s49, s49, 57344
    v_mfma_f32_32x32x16_bf16 v[112:127], v[22:25], v[38:41], v[112:127]
    s_waitcnt vmcnt(6)
    ds_read_b64_tr_b16 v[42:43], v54 offset:6144
    ds_read_b64_tr_b16 v[44:45], v54 offset:7168
    ds_read_b64_tr_b16 v[46:47], v55 offset:6144
    ds_read_b64_tr_b16 v[48:49], v55 offset:7168
    v_mfma_f32_32x32x16_bf16 v[80:95], v[18:21], v[38:41], v[80:95]
    s_waitcnt lgkmcnt(0)
    v_mfma_f32_32x32x16_bf16 v[64:79], v[26:29], v[42:45], v[64:79]
    s_add_u32 m0, s27, 4096
    buffer_load_dwordx4 v[18:21], v52, s[36:39], s49 offen sc1
    buffer_load_dwordx4 v50, s[28:31], s48 offen lds
    v_mfma_f32_32x32x16_bf16 v[96:111], v[30:33], v[42:45], v[96:111]
    buffer_load_dwordx4 v[22:25], v53, s[36:39], s49 offen sc1
    buffer_load_dwordx4 v51, s[28:31], s48 offen offset:1024 lds
    s_add_u32 s48, s48, 262144
    s_add_u32 s49, s49, 57344
    v_mfma_f32_32x32x16_bf16 v[112:127], v[30:33], v[46:49], v[112:127]
    s_waitcnt vmcnt(6)
    ds_read_b64_tr_b16 v[34:35], v54 offset:0
    ds_read_b64_tr_b16 v[36:37], v54 offset:1024
    ds_read_b64_tr_b16 v[38:39], v55 offset:0
    ds_read_b64_tr_b16 v[40:41], v55 offset:1024
    v_mfma_f32_32x32x16_bf16 v[80:95], v[26:29], v[46:49], v[80:95]
    s_waitcnt lgkmcnt(0)
    v_mfma_f32_32x32x16_bf16 v[64:79], v[2:5], v[34:37], v[64:79]
    s_add_u32 m0, s27, 6144
    buffer_load_dwordx4 v[26:29], v52, s[36:39], s49 offen sc1
    buffer_load_dwordx4 v50, s[28:31], s48 offen lds
    v_mfma_f32_32x32x16_bf16 v[96:111], v[6:9], v[34:37], v[96:111]
    buffer_load_dwordx4 v[30:33], v53, s[36:39], s49 offen sc1
    buffer_load_dwordx4 v51, s[28:31], s48 offen offset:1024 lds
    s_add_u32 s48, s48, 262144
    s_add_u32 s49, s49, 57344
    v_mfma_f32_32x32x16_bf16 v[112:127], v[6:9], v[38:41], v[112:127]
    s_waitcnt vmcnt(6)
    ds_read_b64_tr_b16 v[42:43], v54 offset:2048
    ds_read_b64_tr_b16 v[44:45], v54 offset:3072
    ds_read_b64_tr_b16 v[46:47], v55 offset:2048
    ds_read_b64_tr_b16 v[48:49], v55 offset:3072
    v_mfma_f32_32x32x16_bf16 v[80:95], v[2:5], v[38:41], v[80:95]
    s_waitcnt lgkmcnt(0)
    v_mfma_f32_32x32x16_bf16 v[64:79], v[10:13], v[42:45], v[64:79]
    s_add_u32 m0, s27, 0
    buffer_load_dwordx4 v[2:5], v52, s[36:39], s49 offen sc1
    buffer_load_dwordx4 v50, s[28:31], s48 offen lds
    v_mfma_f32_32x32x16_bf16 v[96:111], v[14:17], v[42:45], v[96:111]
    buffer_load_dwordx4 v[6:9], v53, s[36:39], s49 offen sc1
    buffer_load_dwordx4 v51, s[28:31], s48 offen offset:1024 lds
    s_add_u32 s48, s48, 262144
    s_add_u32 s49, s49, 57344
    v_mfma_f32_32x32x16_bf16 v[112:127], v[14:17], v[46:49], v[112:127]
    s_waitcnt vmcnt(6)
    ds_read_b64_tr_b16 v[34:35], v54 offset:4096
    ds_read_b64_tr_b16 v[36:37], v54 offset:5120
    ds_read_b64_tr_b16 v[38:39], v55 offset:4096
    ds_read_b64_tr_b16 v[40:41], v55 offset:5120
    v_mfma_f32_32x32x16_bf16 v[80:95], v[10:13], v[46:49], v[80:95]
    s_waitcnt lgkmcnt(0)
    v_mfma_f32_32x32x16_bf16 v[64:79], v[18:21], v[34:37], v[64:79]
    s_add_u32 m0, s27, 2048
    buffer_load_dwordx4 v[10:13], v52, s[36:39], s49 offen sc1
    buffer_load_dwordx4 v50, s[28:31], s48 offen lds
    v_mfma_f32_32x32x16_bf16 v[96:111], v[22:25], v[34:37], v[96:111]
    buffer_load_dwordx4 v[14:17], v53, s[36:39], s49 offen sc1
    buffer_load_dwordx4 v51, s[28:31], s48 offen offset:1024 lds
    s_add_u32 s48, s48, 262144
    s_add_u32 s49, s49, 57344
    v_mfma_f32_32x32x16_bf16 v[112:127], v[22:25], v[38:41], v[112:127]
    s_waitcnt vmcnt(6)
    ds_read_b64_tr_b16 v[42:43], v54 offset:6144
    ds_read_b64_tr_b16 v[44:45], v54 offset:7168
    ds_read_b64_tr_b16 v[46:47], v55 offset:6144
    ds_read_b64_tr_b16 v[48:49], v55 offset:7168
    v_mfma_f32_32x32x16_bf16 v[80:95], v[18:21], v[38:41], v[80:95]
    s_waitcnt lgkmcnt(0)
    v_mfma_f32_32x32x16_bf16 v[64:79], v[26:29], v[42:45], v[64:79]
    s_add_u32 m0, s27, 4096
    buffer_load_dwordx4 v[18:21], v52, s[36:39], s49 offen sc1
    buffer_load_dwordx4 v50, s[28:31], s48 offen lds
    v_mfma_f32_32x32x16_bf16 v[96:111], v[30:33], v[42:45], v[96:111]
    buffer_load_dwordx4 v[22:25], v53, s[36:39], s49 offen sc1
    buffer_load_dwordx4 v51, s[28:31], s48 offen offset:1024 lds
    s_add_u32 s48, s48, 262144
    s_add_u32 s49, s49, 57344
    v_mfma_f32_32x32x16_bf16 v[112:127], v[30:33], v[46:49], v[112:127]
    s_waitcnt vmcnt(6)
    ds_read_b64_tr_b16 v[34:35], v54 offset:0
    ds_read_b64_tr_b16 v[36:37], v54 offset:1024
    ds_read_b64_tr_b16 v[38:39], v55 offset:0
    ds_read_b64_tr_b16 v[40:41], v55 offset:1024
    v_mfma_f32_32x32x16_bf16 v[80:95], v[26:29], v[46:49], v[80:95]
    s_waitcnt lgkmcnt(0)
    v_mfma_f32_32x32x16_bf16 v[64:79], v[2:5], v[34:37], v[64:79]
    s_add_u32 m0, s27, 6144
    buffer_load_dwordx4 v[26:29], v52, s[36:39], s49 offen sc1
    buffer_load_dwordx4 v50, s[28:31], s48 offen lds
    v_mfma_f32_32x32x16_bf16 v[96:111], v[6:9], v[34:37], v[96:111]
    buffer_load_dwordx4 v[30:33], v53, s[36:39], s49 offen sc1
    buffer_load_dwordx4 v51, s[28:31], s48 offen offset:1024 lds
    s_add_u32 s48, s48, 262144
    s_add_u32 s49, s49, 57344
    v_mfma_f32_32x32x16_bf16 v[112:127], v[6:9], v[38:41], v[112:127]
    s_waitcnt vmcnt(6)
    ds_read_b64_tr_b16 v[42:43], v54 offset:2048
    ds_read_b64_tr_b16 v[44:45], v54 offset:3072
    ds_read_b64_tr_b16 v[46:47], v55 offset:2048
    ds_read_b64_tr_b16 v[48:49], v55 offset:3072
    v_mfma_f32_32x32x16_bf16 v[80:95], v[2:5], v[38:41], v[80:95]
    s_waitcnt lgkmcnt(0)
    v_mfma_f32_32x32x16_bf16 v[64:79], v[10:13], v[42:45], v[64:79]
    s_add_u32 m0, s27, 0
    buffer_load_dwordx4 v[2:5], v52, s[36:39], s49 offen sc1
    buffer_load_dwordx4 v50, s[28:31], s48 offen lds
    v_mfma_f32_32x32x16_bf16 v[96:111], v[14:17], v[42:45], v[96:111]
    buffer_load_dwordx4 v[6:9], v53, s[36:39], s49 offen sc1
    buffer_load_dwordx4 v51, s[28:31], s48 offen offset:1024 lds
    s_add_u32 s48, s48, 262144
    s_add_u32 s49, s49, 57344
    v_mfma_f32_32x32x16_bf16 v[112:127], v[14:17], v[46:49], v[112:127]
    s_waitcnt vmcnt(6)
    ds_read_b64_tr_b16 v[34:35], v54 offset:4096
    ds_read_b64_tr_b16 v[36:37], v54 offset:5120
    ds_read_b64_tr_b16 v[38:39], v55 offset:4096
    ds_read_b64_tr_b16 v[40:41], v55 offset:5120
    v_mfma_f32_32x32x16_bf16 v[80:95], v[10:13], v[46:49], v[80:95]
    s_waitcnt lgkmcnt(0)
    v_mfma_f32_32x32x16_bf16 v[64:79], v[18:21], v[34:37], v[64:79]
    s_add_u32 m0, s27, 2048
    buffer_load_dwordx4 v[10:13], v52, s[36:39], s49 offen sc1
    buffer_load_dwordx4 v50, s[28:31], s48 offen lds
    v_mfma_f32_32x32x16_bf16 v[96:111], v[22:25], v[34:37], v[96:111]
    buffer_load_dwordx4 v[14:17], v53, s[36:39], s49 offen sc1
    buffer_load_dwordx4 v51, s[28:31], s48 offen offset:1024 lds
    s_add_u32 s48, s48, 262144
    s_add_u32 s49, s49, 57344
    v_mfma_f32_32x32x16_bf16 v[112:127], v[22:25], v[38:41], v[112:127]
    s_waitcnt vmcnt(6)
    ds_read_b64_tr_b16 v[42:43], v54 offset:6144
    ds_read_b64_tr_b16 v[44:45], v54 offset:7168
    ds_read_b64_tr_b16 v[46:47], v55 offset:6144
    ds_read_b64_tr_b16 v[48:49], v55 offset:7168
    v_mfma_f32_32x32x16_bf16 v[80:95], v[18:21], v[38:41], v[80:95]
    s_waitcnt lgkmcnt(0)
    v_mfma_f32_32x32x16_bf16 v[64:79], v[26:29], v[42:45], v[64:79]
    s_add_u32 m0, s27, 4096
    buffer_load_dwordx4 v[18:21], v52, s[36:39], s49 offen sc1
    buffer_load_dwordx4 v50, s[28:31], s48 offen lds
    v_mfma_f32_32x32x16_bf16 v[96:111], v[30:33], v[42:45], v[96:111]
    buffer_load_dwordx4 v[22:25], v53, s[36:39], s49 offen sc1
    buffer_load_dwordx4 v51, s[28:31], s48 offen offset:1024 lds
    s_add_u32 s48, s48, 262144
    s_add_u32 s49, s49, 57344
    v_mfma_f32_32x32x16_bf16 v[112:127], v[30:33], v[46:49], v[112:127]
    s_waitcnt vmcnt(6)
    ds_read_b64_tr_b16 v[34:35], v54 offset:0
    ds_read_b64_tr_b16 v[36:37], v54 offset:1024
    ds_read_b64_tr_b16 v[38:39], v55 offset:0
    ds_read_b64_tr_b16 v[40:41], v55 offset:1024
    v_mfma_f32_32x32x16_bf16 v[80:95], v[26:29], v[46:49], v[80:95]
    s_waitcnt lgkmcnt(0)
    v_mfma_f32_32x32x16_bf16 v[64:79], v[2:5], v[34:37], v[64:79]
    s_add_u32 m0, s27, 6144
    buffer_load_dwordx4 v[26:29], v52, s[36:39], s49 offen sc1
    buffer_load_dwordx4 v50, s[28:31], s48 offen lds
    v_mfma_f32_32x32x16_bf16 v[96:111], v[6:9], v[34:37], v[96:111]
    buffer_load_dwordx4 v[30:33], v53, s[36:39], s49 offen sc1
    buffer_load_dwordx4 v51, s[28:31], s48 offen offset:1024 lds
    s_add_u32 s48, s48, 262144
    s_add_u32 s49, s49, 57344
    v_mfma_f32_32x32x16_bf16 v[112:127], v[6:9], v[38:41], v[112:127]
    s_waitcnt vmcnt(6)
    ds_read_b64_tr_b16 v[42:43], v54 offset:2048
    ds_read_b64_tr_b16 v[44:45], v54 offset:3072
    ds_read_b64_tr_b16 v[46:47], v55 offset:2048
    ds_read_b64_tr_b16 v[48:49], v55 offset:3072
    v_mfma_f32_32x32x16_bf16 v[80:95], v[2:5], v[38:41], v[80:95]
    s_waitcnt lgkmcnt(0)
    v_mfma_f32_32x32x16_bf16 v[64:79], v[10:13], v[42:45], v[64:79]
    s_add_u32 m0, s27, 0
    buffer_load_dwordx4 v[2:5], v52, s[36:39], s49 offen sc1
    buffer_load_dwordx4 v50, s[28:31], s48 offen lds
    v_mfma_f32_32x32x16_bf16 v[96:111], v[14:17], v[42:45], v[96:111]
    buffer_load_dwordx4 v[6:9], v53, s[36:39], s49 offen sc1
    buffer_load_dwordx4 v51, s[28:31], s48 offen offset:1024 lds
    s_add_u32 s48, s48, 262144
    s_add_u32 s49, s49, 57344
    v_mfma_f32_32x32x16_bf16 v[112:127], v[14:17], v[46:49], v[112:127]
    s_waitcnt vmcnt(6)
    ds_read_b64_tr_b16 v[34:35], v54 offset:4096
    ds_read_b64_tr_b16 v[36:37], v54 offset:5120
    ds_read_b64_tr_b16 v[38:39], v55 offset:4096
    ds_read_b64_tr_b16 v[40:41], v55 offset:5120
    v_mfma_f32_32x32x16_bf16 v[80:95], v[10:13], v[46:49], v[80:95]
    s_waitcnt lgkmcnt(0)
    v_mfma_f32_32x32x16_bf16 v[64:79], v[18:21], v[34:37], v[64:79]
    s_add_u32 m0, s27, 2048
    buffer_load_dwordx4 v[10:13], v52, s[36:39], s49 offen sc1
    buffer_load_dwordx4 v50, s[28:31], s48 offen lds
    v_mfma_f32_32x32x16_bf16 v[96:111], v[22:25], v[34:37], v[96:111]
    buffer_load_dwordx4 v[14:17], v53, s[36:39], s49 offen sc1
    buffer_load_dwordx4 v51, s[28:31], s48 offen offset:1024 lds
    s_add_u32 s48, s48, 262144
    s_add_u32 s49, s49, 57344
    v_mfma_f32_32x32x16_bf16 v[112:127], v[22:25], v[38:41], v[112:127]
    s_waitcnt vmcnt(6)
    ds_read_b64_tr_b16 v[42:43], v54 offset:6144
    ds_read_b64_tr_b16 v[44:45], v54 offset:7168
    ds_read_b64_tr_b16 v[46:47], v55 offset:6144
    ds_read_b64_tr_b16 v[48:49], v55 offset:7168
    v_mfma_f32_32x32x16_bf16 v[80:95], v[18:21], v[38:41], v[80:95]
    s_waitcnt lgkmcnt(0)
    v_mfma_f32_32x32x16_bf16 v[64:79], v[26:29], v[42:45], v[64:79]
    s_add_u32 m0, s27, 4096
    buffer_load_dwordx4 v[18:21], v52, s[36:39], s49 offen sc1
    buffer_load_dwordx4 v50, s[28:31], s48 offen lds
    v_mfma_f32_32x32x16_bf16 v[96:111], v[30:33], v[42:45], v[96:111]
    buffer_load_dwordx4 v[22:25], v53, s[36:39], s49 offen sc1
    buffer_load_dwordx4 v51, s[28:31], s48 offen offset:1024 lds
    s_add_u32 s48, s48, 262144
    s_add_u32 s49, s49, 57344
    v_mfma_f32_32x32x16_bf16 v[112:127], v[30:33], v[46:49], v[112:127]
    s_waitcnt vmcnt(6)
    ds_read_b64_tr_b16 v[34:35], v54 offset:0
    ds_read_b64_tr_b16 v[36:37], v54 offset:1024
    ds_read_b64_tr_b16 v[38:39], v55 offset:0
    ds_read_b64_tr_b16 v[40:41], v55 offset:1024
    v_mfma_f32_32x32x16_bf16 v[80:95], v[26:29], v[46:49], v[80:95]
    s_waitcnt lgkmcnt(0)
    v_mfma_f32_32x32x16_bf16 v[64:79], v[2:5], v[34:37], v[64:79]
    s_add_u32 m0, s27, 6144
    buffer_load_dwordx4 v[26:29], v52, s[36:39], s49 offen sc1
    buffer_load_dwordx4 v50, s[28:31], s48 offen lds
    v_mfma_f32_32x32x16_bf16 v[96:111], v[6:9], v[34:37], v[96:111]
    buffer_load_dwordx4 v[30:33], v53, s[36:39], s49 offen sc1
    buffer_load_dwordx4 v51, s[28:31], s48 offen offset:1024 lds
    s_add_u32 s48, s48, 262144
    s_add_u32 s49, s49, 57344
    v_mfma_f32_32x32x16_bf16 v[112:127], v[6:9], v[38:41], v[112:127]
    s_waitcnt vmcnt(6)
    ds_read_b64_tr_b16 v[42:43], v54 offset:2048
    ds_read_b64_tr_b16 v[44:45], v54 offset:3072
    ds_read_b64_tr_b16 v[46:47], v55 offset:2048
    ds_read_b64_tr_b16 v[48:49], v55 offset:3072
    v_mfma_f32_32x32x16_bf16 v[80:95], v[2:5], v[38:41], v[80:95]
    s_waitcnt lgkmcnt(0)
    v_mfma_f32_32x32x16_bf16 v[64:79], v[10:13], v[42:45], v[64:79]
    s_add_u32 m0, s27, 0
    buffer_load_dwordx4 v[2:5], v52, s[36:39], s49 offen sc1
    buffer_load_dwordx4 v50, s[28:31], s48 offen lds
    v_mfma_f32_32x32x16_bf16 v[96:111], v[14:17], v[42:45], v[96:111]
    buffer_load_dwordx4 v[6:9], v53, s[36:39], s49 offen sc1
    buffer_load_dwordx4 v51, s[28:31], s48 offen offset:1024 lds
    s_add_u32 s48, s48, 262144
    s_add_u32 s49, s49, 57344
    v_mfma_f32_32x32x16_bf16 v[112:127], v[14:17], v[46:49], v[112:127]
    s_waitcnt vmcnt(6)
    ds_read_b64_tr_b16 v[34:35], v54 offset:4096
    ds_read_b64_tr_b16 v[36:37], v54 offset:5120
    ds_read_b64_tr_b16 v[38:39], v55 offset:4096
    ds_read_b64_tr_b16 v[40:41], v55 offset:5120
    v_mfma_f32_32x32x16_bf16 v[80:95], v[10:13], v[46:49], v[80:95]
    s_waitcnt lgkmcnt(0)
    v_mfma_f32_32x32x16_bf16 v[64:79], v[18:21], v[34:37], v[64:79]
    s_add_u32 m0, s27, 2048
    buffer_load_dwordx4 v[10:13], v52, s[36:39], s49 offen sc1
    buffer_load_dwordx4 v50, s[28:31], s48 offen lds
    v_mfma_f32_32x32x16_bf16 v[96:111], v[22:25], v[34:37], v[96:111]
    buffer_load_dwordx4 v[14:17], v53, s[36:39], s49 offen sc1
    buffer_load_dwordx4 v51, s[28:31], s48 offen offset:1024 lds
    s_add_u32 s48, s48, 262144
    s_add_u32 s49, s49, 57344
    v_mfma_f32_32x32x16_bf16 v[112:127], v[22:25], v[38:41], v[112:127]
    s_waitcnt vmcnt(6)
    ds_read_b64_tr_b16 v[42:43], v54 offset:6144
    ds_read_b64_tr_b16 v[44:45], v54 offset:7168
    ds_read_b64_tr_b16 v[46:47], v55 offset:6144
    ds_read_b64_tr_b16 v[48:49], v55 offset:7168
    v_mfma_f32_32x32x16_bf16 v[80:95], v[18:21], v[38:41], v[80:95]
    s_waitcnt lgkmcnt(0)
    v_mfma_f32_32x32x16_bf16 v[64:79], v[26:29], v[42:45], v[64:79]
    s_add_u32 m0, s27, 4096
    buffer_load_dwordx4 v[18:21], v52, s[36:39], s49 offen sc1
    buffer_load_dwordx4 v50, s[28:31], s48 offen lds
    v_mfma_f32_32x32x16_bf16 v[96:111], v[30:33], v[42:45], v[96:111]
    buffer_load_dwordx4 v[22:25], v53, s[36:39], s49 offen sc1
    buffer_load_dwordx4 v51, s[28:31], s48 offen offset:1024 lds
    s_add_u32 s48, s48, 262144
    s_add_u32 s49, s49, 57344
    v_mfma_f32_32x32x16_bf16 v[112:127], v[30:33], v[46:49], v[112:127]
    s_waitcnt vmcnt(6)
    ds_read_b64_tr_b16 v[34:35], v54 offset:0
    ds_read_b64_tr_b16 v[36:37], v54 offset:1024
    ds_read_b64_tr_b16 v[38:39], v55 offset:0
    ds_read_b64_tr_b16 v[40:41], v55 offset:1024
    v_mfma_f32_32x32x16_bf16 v[80:95], v[26:29], v[46:49], v[80:95]
    s_waitcnt lgkmcnt(0)
    v_mfma_f32_32x32x16_bf16 v[64:79], v[2:5], v[34:37], v[64:79]
    s_add_u32 m0, s27, 6144
    buffer_load_dwordx4 v[26:29], v52, s[36:39], s49 offen sc1
    buffer_load_dwordx4 v50, s[28:31], s48 offen lds
    v_mfma_f32_32x32x16_bf16 v[96:111], v[6:9], v[34:37], v[96:111]
    buffer_load_dwordx4 v[30:33], v53, s[36:39], s49 offen sc1
    buffer_load_dwordx4 v51, s[28:31], s48 offen offset:1024 lds
    s_add_u32 s48, s48, 262144
    s_add_u32 s49, s49, 57344
    v_mfma_f32_32x32x16_bf16 v[112:127], v[6:9], v[38:41], v[112:127]
    s_waitcnt vmcnt(6)
    ds_read_b64_tr_b16 v[42:43], v54 offset:2048
    ds_read_b64_tr_b16 v[44:45], v54 offset:3072
    ds_read_b64_tr_b16 v[46:47], v55 offset:2048
    ds_read_b64_tr_b16 v[48:49], v55 offset:3072
    v_mfma_f32_32x32x16_bf16 v[80:95], v[2:5], v[38:41], v[80:95]
    s_waitcnt lgkmcnt(0)
    v_mfma_f32_32x32x16_bf16 v[64:79], v[10:13], v[42:45], v[64:79]
    v_mfma_f32_32x32x16_bf16 v[96:111], v[14:17], v[42:45], v[96:111]
    v_mfma_f32_32x32x16_bf16 v[112:127], v[14:17], v[46:49], v[112:127]
    s_waitcnt vmcnt(4)
    ds_read_b64_tr_b16 v[34:35], v54 offset:4096
    ds_read_b64_tr_b16 v[36:37], v54 offset:5120
    ds_read_b64_tr_b16 v[38:39], v55 offset:4096
    ds_read_b64_tr_b16 v[40:41], v55 offset:5120
    v_mfma_f32_32x32x16_bf16 v[80:95], v[10:13], v[46:49], v[80:95]
    s_waitcnt lgkmcnt(0)
    v_mfma_f32_32x32x16_bf16 v[64:79], v[18:21], v[34:37], v[64:79]
    v_mfma_f32_32x32x16_bf16 v[96:111], v[22:25], v[34:37], v[96:111]
    v_mfma_f32_32x32x16_bf16 v[112:127], v[22:25], v[38:41], v[112:127]
    s_waitcnt vmcnt(0)
    ds_read_b64_tr_b16 v[42:43], v54 offset:6144
    ds_read_b64_tr_b16 v[44:45], v54 offset:7168
    ds_read_b64_tr_b16 v[46:47], v55 offset:6144
    ds_read_b64_tr_b16 v[48:49], v55 offset:7168
    v_mfma_f32_32x32x16_bf16 v[80:95], v[18:21], v[38:41], v[80:95]
    s_waitcnt lgkmcnt(0)
    v_mfma_f32_32x32x16_bf16 v[64:79], v[26:29], v[42:45], v[64:79]
    v_mfma_f32_32x32x16_bf16 v[96:111], v[30:33], v[42:45], v[96:111]
    v_mfma_f32_32x32x16_bf16 v[112:127], v[30:33], v[46:49], v[112:127]
    v_mfma_f32_32x32x16_bf16 v[80:95], v[26:29], v[46:49], v[80:95]
    s_lshl_b32 s53, s51, 7
    s_mul_i32 s52, s26, 57344
    s_add_u32 s52, s52, s53
    s_mul_i32 s61, s26, 50176
    s_add_u32 s61, s61, s53
    s_add_u32 s61, s61, 229376
    s_setprio 2
    v_lshrrev_b32 v2, 3, v1
    v_and_b32 v3, 7, v1
    v_bfe_u32 v50, v1, 4, 1
    v_lshlrev_b32 v50, 2, v50
    v_xor_b32 v3, v3, v50
    v_mul_u32_u24 v2, 896, v2
    v_lshl_add_u32 v50, v3, 4, v2
    s_add_u32 m0, s27, 0
    s_nop 0
    buffer_load_dwordx4 v50, s[32:35], s52 offen lds
    s_add_u32 s52, s52, 7168
    s_add_u32 m0, s27, 1024
    s_nop 0
    buffer_load_dwordx4 v50, s[32:35], s52 offen lds
    s_add_u32 s52, s52, 7168
    s_add_u32 m0, s27, 2048
    s_nop 0
    buffer_load_dwordx4 v50, s[32:35], s52 offen lds
    s_add_u32 s52, s52, 7168
    s_add_u32 m0, s27, 3072
    s_nop 0
    buffer_load_dwordx4 v50, s[32:35], s52 offen lds
    s_add_u32 s52, s52, 7168
    s_add_u32 m0, s27, 4096
    s_nop 0
    buffer_load_dwordx4 v50, s[32:35], s52 offen lds
    s_add_u32 s52, s52, 7168
    s_add_u32 m0, s27, 5120
    s_nop 0
    buffer_load_dwordx4 v50, s[32:35], s52 offen lds
    s_add_u32 s52, s52, 7168
    s_add_u32 m0, s27, 6144
    s_nop 0
    buffer_load_dwordx4 v50, s[32:35], s52 offen lds
    s_add_u32 s52, s52, 7168
    s_add_u32 m0, s27, 7168
    s_nop 0
    buffer_load_dwordx4 v50, s[32:35], s52 offen lds
    s_add_u32 s52, s52, 7168
    v_lshlrev_b32 v16, 4, v1
    v_add_u32 v16, 32768, v16
    s_mul_i32 s53, s26, 12288
    v_add_u32 v17, s53, v16
    s_cmp_eq_u32 s26, 1
    s_cbranch_scc1 fin_r1
    s_cmp_eq_u32 s26, 2
    s_cbranch_scc1 fin_r2
    s_cmp_eq_u32 s26, 3
    s_cbranch_scc1 fin_r3
    s_nop 7
    ds_write_b128 v16, v[80:83] offset:20480
    ds_write_b128 v16, v[84:87] offset:21504
    ds_write_b128 v16, v[88:91] offset:22528
    ds_write_b128 v16, v[92:95] offset:23552
    ds_write_b128 v16, v[96:99] offset:28672
    ds_write_b128 v16, v[100:103] offset:29696
    ds_write_b128 v16, v[104:107] offset:30720
    ds_write_b128 v16, v[108:111] offset:31744
    ds_write_b128 v16, v[112:115] offset:36864
    ds_write_b128 v16, v[116:119] offset:37888
    ds_write_b128 v16, v[120:123] offset:38912
    ds_write_b128 v16, v[124:127] offset:39936
    v_lshlrev_b32 v18, 16, v56
    v_and_b32 v19, 0xffff0000, v56
    v_lshlrev_b32 v20, 16, v57
    v_and_b32 v21, 0xffff0000, v57
    v_lshlrev_b32 v22, 16, v58
    v_and_b32 v23, 0xffff0000, v58
    v_lshlrev_b32 v24, 16, v59
    v_and_b32 v25, 0xffff0000, v59
    v_lshlrev_b32 v26, 16, v60
    v_and_b32 v27, 0xffff0000, v60
    v_lshlrev_b32 v28, 16, v61
    v_and_b32 v29, 0xffff0000, v61
    v_lshlrev_b32 v30, 16, v62
    v_and_b32 v31, 0xffff0000, v62
    v_lshlrev_b32 v32, 16, v63
    v_and_b32 v33, 0xffff0000, v63
    v_pk_add_f32 v[18:19], v[18:19], v[64:65]
    v_pk_add_f32 v[20:21], v[20:21], v[66:67]
    v_pk_add_f32 v[22:23], v[22:23], v[68:69]
    v_pk_add_f32 v[24:25], v[24:25], v[70:71]
    v_pk_add_f32 v[26:27], v[26:27], v[72:73]
    v_pk_add_f32 v[28:29], v[28:29], v[74:75]
    v_pk_add_f32 v[30:31], v[30:31], v[76:77]
    v_pk_add_f32 v[32:33], v[32:33], v[78:79]
    s_branch fin_rj
fin_r1:
    s_nop 7
    ds_write_b128 v16, v[64:67] offset:0
    ds_write_b128 v16, v[68:71] offset:1024
    ds_write_b128 v16, v[72:75] offset:2048
    ds_write_b128 v16, v[76:79] offset:3072
    ds_write_b128 v16, v[96:99] offset:32768
    ds_write_b128 v16, v[100:103] offset:33792
    ds_write_b128 v16, v[104:107] offset:34816
    ds_write_b128 v16, v[108:111] offset:35840
    ds_write_b128 v16, v[112:115] offset:40960
    ds_write_b128 v16, v[116:119] offset:41984
    ds_write_b128 v16, v[120:123] offset:43008
    ds_write_b128 v16, v[124:127] offset:44032
    v_lshlrev_b32 v18, 16, v56
    v_and_b32 v19, 0xffff0000, v56
    v_lshlrev_b32 v20, 16, v57
    v_and_b32 v21, 0xffff0000, v57
    v_lshlrev_b32 v22, 16, v58
    v_and_b32 v23, 0xffff0000, v58
    v_lshlrev_b32 v24, 16, v59
    v_and_b32 v25, 0xffff0000, v59
    v_lshlrev_b32 v26, 16, v60
    v_and_b32 v27, 0xffff0000, v60
    v_lshlrev_b32 v28, 16, v61
    v_and_b32 v29, 0xffff0000, v61
    v_lshlrev_b32 v30, 16, v62
    v_and_b32 v31, 0xffff0000, v62
    v_lshlrev_b32 v32, 16, v63
    v_and_b32 v33, 0xffff0000, v63
    v_pk_add_f32 v[18:19], v[18:19], v[80:81]
    v_pk_add_f32 v[20:21], v[20:21], v[82:83]
    v_pk_add_f32 v[22:23], v[22:23], v[84:85]
    v_pk_add_f32 v[24:25], v[24:25], v[86:87]
    v_pk_add_f32 v[26:27], v[26:27], v[88:89]
    v_pk_add_f32 v[28:29], v[28:29], v[90:91]
    v_pk_add_f32 v[30:31], v[30:31], v[92:93]
    v_pk_add_f32 v[32:33], v[32:33], v[94:95]
    s_branch fin_rj
fin_r2:
    s_nop 7
    ds_write_b128 v16, v[64:67] offset:4096
    ds_write_b128 v16, v[68:71] offset:5120
    ds_write_b128 v16, v[72:75] offset:6144
    ds_write_b128 v16, v[76:79] offset:7168
    ds_write_b128 v16, v[80:83] offset:12288
    ds_write_b128 v16, v[84:87] offset:13312
    ds_write_b128 v16, v[88:91] offset:14336
    ds_write_b128 v16, v[92:95] offset:15360
    ds_write_b128 v16, v[112:115] offset:45056
    ds_write_b128 v16, v[116:119] offset:46080
    ds_write_b128 v16, v[120:123] offset:47104
    ds_write_b128 v16, v[124:127] offset:48128
    v_lshlrev_b32 v18, 16, v56
    v_and_b32 v19, 0xffff0000, v56
    v_lshlrev_b32 v20, 16, v57
    v_and_b32 v21, 0xffff0000, v57
    v_lshlrev_b32 v22, 16, v58
    v_and_b32 v23, 0xffff0000, v58
    v_lshlrev_b32 v24, 16, v59
    v_and_b32 v25, 0xffff0000, v59
    v_lshlrev_b32 v26, 16, v60
    v_and_b32 v27, 0xffff0000, v60
    v_lshlrev_b32 v28, 16, v61
    v_and_b32 v29, 0xffff0000, v61
    v_lshlrev_b32 v30, 16, v62
    v_and_b32 v31, 0xffff0000, v62
    v_lshlrev_b32 v32, 16, v63
    v_and_b32 v33, 0xffff0000, v63
    v_pk_add_f32 v[18:19], v[18:19], v[96:97]
    v_pk_add_f32 v[20:21], v[20:21], v[98:99]
    v_pk_add_f32 v[22:23], v[22:23], v[100:101]
    v_pk_add_f32 v[24:25], v[24:25], v[102:103]
    v_pk_add_f32 v[26:27], v[26:27], v[104:105]
    v_pk_add_f32 v[28:29], v[28:29], v[106:107]
    v_pk_add_f32 v[30:31], v[30:31], v[108:109]
    v_pk_add_f32 v[32:33], v[32:33], v[110:111]
    s_branch fin_rj
fin_r3:
    s_nop 7
    ds_write_b128 v16, v[64:67] offset:8192
    ds_write_b128 v16, v[68:71] offset:9216
    ds_write_b128 v16, v[72:75] offset:10240
    ds_write_b128 v16, v[76:79] offset:11264
    ds_write_b128 v16, v[80:83] offset:16384
    ds_write_b128 v16, v[84:87] offset:17408
    ds_write_b128 v16, v[88:91] offset:18432
    ds_write_b128 v16, v[92:95] offset:19456
    ds_write_b128 v16, v[96:99] offset:24576
    ds_write_b128 v16, v[100:103] offset:25600
    ds_write_b128 v16, v[104:107] offset:26624
    ds_write_b128 v16, v[108:111] offset:27648
    v_lshlrev_b32 v18, 16, v56
    v_and_b32 v19, 0xffff0000, v56
    v_lshlrev_b32 v20, 16, v57
    v_and_b32 v21, 0xffff0000, v57
    v_lshlrev_b32 v22, 16, v58
    v_and_b32 v23, 0xffff0000, v58
    v_lshlrev_b32 v24, 16, v59
    v_and_b32 v25, 0xffff0000, v59
    v_lshlrev_b32 v26, 16, v60
    v_and_b32 v27, 0xffff0000, v60
    v_lshlrev_b32 v28, 16, v61
    v_and_b32 v29, 0xffff0000, v61
    v_lshlrev_b32 v30, 16, v62
    v_and_b32 v31, 0xffff0000, v62
    v_lshlrev_b32 v32, 16, v63
    v_and_b32 v33, 0xffff0000, v63
    v_pk_add_f32 v[18:19], v[18:19], v[112:113]
    v_pk_add_f32 v[20:21], v[20:21], v[114:115]
    v_pk_add_f32 v[22:23], v[22:23], v[116:117]
    v_pk_add_f32 v[24:25], v[24:25], v[118:119]
    v_pk_add_f32 v[26:27], v[26:27], v[120:121]
    v_pk_add_f32 v[28:29], v[28:29], v[122:123]
    v_pk_add_f32 v[30:31], v[30:31], v[124:125]
    v_pk_add_f32 v[32:33], v[32:33], v[126:127]
fin_rj:
    s_waitcnt lgkmcnt(0)
    s_barrier
    ds_read_b128 v[64:67], v17 offset:0
    ds_read_b128 v[68:71], v17 offset:1024
    ds_read_b128 v[72:75], v17 offset:2048
    ds_read_b128 v[76:79], v17 offset:3072
    ds_read_b128 v[80:83], v17 offset:4096
    ds_read_b128 v[84:87], v17 offset:5120
    ds_read_b128 v[88:91], v17 offset:6144
    ds_read_b128 v[92:95], v17 offset:7168
    ds_read_b128 v[96:99], v17 offset:8192
    ds_read_b128 v[100:103], v17 offset:9216
    ds_read_b128 v[104:107], v17 offset:10240
    ds_read_b128 v[108:111], v17 offset:11264
    s_waitcnt lgkmcnt(8)
    v_pk_add_f32 v[18:19], v[18:19], v[64:65]
    v_pk_add_f32 v[20:21], v[20:21], v[66:67]
    v_pk_add_f32 v[22:23], v[22:23], v[68:69]
    v_pk_add_f32 v[24:25], v[24:25], v[70:71]
    v_pk_add_f32 v[26:27], v[26:27], v[72:73]
    v_pk_add_f32 v[28:29], v[28:29], v[74:75]
    v_pk_add_f32 v[30:31], v[30:31], v[76:77]
    v_pk_add_f32 v[32:33], v[32:33], v[78:79]
    s_waitcnt lgkmcnt(4)
    v_pk_add_f32 v[18:19], v[18:19], v[80:81]
    v_pk_add_f32 v[20:21], v[20:21], v[82:83]
    v_pk_add_f32 v[22:23], v[22:23], v[84:85]
    v_pk_add_f32 v[24:25], v[24:25], v[86:87]
    v_pk_add_f32 v[26:27], v[26:27], v[88:89]
    v_pk_add_f32 v[28:29], v[28:29], v[90:91]
    v_pk_add_f32 v[30:31], v[30:31], v[92:93]
    v_pk_add_f32 v[32:33], v[32:33], v[94:95]
    s_waitcnt lgkmcnt(0)
    v_pk_add_f32 v[18:19], v[18:19], v[96:97]
    v_pk_add_f32 v[20:21], v[20:21], v[98:99]
    v_pk_add_f32 v[22:23], v[22:23], v[100:101]
    v_pk_add_f32 v[24:25], v[24:25], v[102:103]
    v_pk_add_f32 v[26:27], v[26:27], v[104:105]
    v_pk_add_f32 v[28:29], v[28:29], v[106:107]
    v_pk_add_f32 v[30:31], v[30:31], v[108:109]
    v_pk_add_f32 v[32:33], v[32:33], v[110:111]
    s_barrier
    s_mul_i32 s53, s26, 7168
    s_add_u32 m0, s53, 32768
    s_nop 0
    buffer_load_dwordx4 v50, s[32:35], s61 offen lds
    s_add_u32 s61, s61, 7168
    s_add_u32 m0, s53, 33792
    s_nop 0
    buffer_load_dwordx4 v50, s[32:35], s61 offen lds
    s_add_u32 s61, s61, 7168
    s_add_u32 m0, s53, 34816
    s_nop 0
    buffer_load_dwordx4 v50, s[32:35], s61 offen lds
    s_add_u32 s61, s61, 7168
    s_add_u32 m0, s53, 35840
    s_nop 0
    buffer_load_dwordx4 v50, s[32:35], s61 offen lds
    s_add_u32 s61, s61, 7168
    s_add_u32 m0, s53, 36864
    s_nop 0
    buffer_load_dwordx4 v50, s[32:35], s61 offen lds
    s_add_u32 s61, s61, 7168
    s_add_u32 m0, s53, 37888
    s_nop 0
    buffer_load_dwordx4 v50, s[32:35], s61 offen lds
    s_add_u32 s61, s61, 7168
    s_add_u32 m0, s53, 38912
    s_nop 0
    buffer_load_dwordx4 v50, s[32:35], s61 offen lds
    s_add_u32 s61, s61, 7168
    s_mul_i32 s53, s55, 28672
    s_sub_u32 s53, s53, s27
    s_lshl_b32 s54, s55, 6
    v_add_u32 v54, s53, v54
    v_xor_b32 v54, s54, v54
    v_xor_b32 v55, 64, v54
    v_lshlrev_b32 v10, 16, v0
    v_lshlrev_b32 v11, 16, v0
    v_and_b32 v2, 31, v1
    v_lshrrev_b32 v3, 5, v1
    v_lshlrev_b32 v52, 4, v2
    v_lshl_add_u32 v52, v3, 15, v52
    v_mul_u32_u24 v2, 896, v2
    v_lshl_add_u32 v58, v3, 4, v2
    v_add_u32 v59, 32, v58
    v_pk_add_f32 v[18:19], v[18:19], v[10:11]
    v_pk_add_f32 v[20:21], v[20:21], v[10:11]
    v_pk_add_f32 v[22:23], v[22:23], v[10:11]
    v_pk_add_f32 v[24:25], v[24:25], v[10:11]
    v_pk_add_f32 v[26:27], v[26:27], v[10:11]
    v_pk_add_f32 v[28:29], v[28:29], v[10:11]
    v_pk_add_f32 v[30:31], v[30:31], v[10:11]
    v_pk_add_f32 v[32:33], v[32:33], v[10:11]
    s_mov_b32 s40, s20
    s_mov_b32 s41, s21
    s_mov_b32 s42, 1835008
    s_mov_b32 s43, 0x20000
    s_xor_b32 s53, s26, 2
    s_lshl_b32 s53, s53, 12
    s_add_u32 s53, s53, 65536
    s_lshl_b32 s54, s26, 12
    s_add_u32 s54, s54, 65536
    v_lshlrev_b32 v62, 4, v1
    v_add_u32 v63, s54, v62
    v_add_u32 v62, s53, v62
    s_waitcnt vmcnt(0)
    s_barrier
    buffer_load_dwordx4 v[64:67], v52, s[36:39], s58 offen sc1
    s_add_u32 s58, s58, 65536
    buffer_load_dwordx4 v[68:71], v52, s[36:39], s58 offen sc1
    s_add_u32 s58, s58, 65536
    buffer_load_dwordx4 v[72:75], v52, s[36:39], s58 offen sc1
    s_add_u32 s58, s58, 65536
    buffer_load_dwordx4 v[76:79], v52, s[36:39], s58 offen sc1
    s_add_u32 s58, s58, 65536
    buffer_load_dwordx4 v[80:83], v52, s[36:39], s58 offen sc1
    s_add_u32 s58, s58, 65536
    buffer_load_dwordx4 v[84:87], v52, s[36:39], s58 offen sc1
    s_add_u32 s58, s58, 65536
    buffer_load_dwordx4 v[88:91], v52, s[36:39], s58 offen sc1
    s_add_u32 s58, s58, 65536
    buffer_load_dwordx4 v[92:95], v52, s[36:39], s58 offen sc1
    s_add_u32 s58, s58, 65536
    buffer_load_dwordx4 v[96:99], v52, s[36:39], s58 offen sc1
    s_add_u32 s58, s58, 65536
    buffer_load_dwordx4 v[100:103], v52, s[36:39], s58 offen sc1
    s_add_u32 s58, s58, 65536
    buffer_load_dwordx4 v[104:107], v52, s[36:39], s58 offen sc1
    s_add_u32 s58, s58, 65536
    buffer_load_dwordx4 v[108:111], v52, s[36:39], s58 offen sc1
    s_add_u32 s58, s58, 65536
    buffer_load_dwordx4 v[112:115], v52, s[36:39], s58 offen sc1
    s_add_u32 s58, s58, 65536
    buffer_load_dwordx4 v[116:119], v52, s[36:39], s58 offen sc1
    s_add_u32 s58, s58, 65536
    buffer_load_dwordx4 v[120:123], v52, s[36:39], s58 offen sc1
    s_add_u32 s58, s58, 65536
    buffer_load_dwordx4 v[124:127], v52, s[36:39], s58 offen sc1
    s_add_u32 s58, s58, 65536
    ds_read_b64_tr_b16 v[2:3], v54 offset:0
    ds_read_b64_tr_b16 v[4:5], v54 offset:1024
    ds_read_b64_tr_b16 v[6:7], v55 offset:0
    ds_read_b64_tr_b16 v[8:9], v55 offset:1024
    ds_read_b64_tr_b16 v[10:11], v54 offset:2048
    ds_read_b64_tr_b16 v[12:13], v54 offset:3072
    ds_read_b64_tr_b16 v[14:15], v55 offset:2048
    ds_read_b64_tr_b16 v[16:17], v55 offset:3072
    s_waitcnt vmcnt(15) lgkmcnt(4)
    v_mfma_f32_32x32x16_bf16 v[34:49], v[6:9], v[64:67], 0
    v_mfma_f32_32x32x16_bf16 v[18:33], v[2:5], v[64:67], v[18:33]
    ds_read_b64_tr_b16 v[2:3], v54 offset:3584
    ds_read_b64_tr_b16 v[4:5], v54 offset:4608
    ds_read_b64_tr_b16 v[6:7], v55 offset:3584
    ds_read_b64_tr_b16 v[8:9], v55 offset:4608
    s_waitcnt vmcnt(14) lgkmcnt(4)
    v_mfma_f32_32x32x16_bf16 v[34:49], v[14:17], v[68:71], v[34:49]
    v_mfma_f32_32x32x16_bf16 v[18:33], v[10:13], v[68:71], v[18:33]
    ds_read_b64_tr_b16 v[10:11], v54 offset:5632
    ds_read_b64_tr_b16 v[12:13], v54 offset:6656
    ds_read_b64_tr_b16 v[14:15], v55 offset:5632
    ds_read_b64_tr_b16 v[16:17], v55 offset:6656
    s_waitcnt vmcnt(13) lgkmcnt(4)
    v_mfma_f32_32x32x16_bf16 v[34:49], v[6:9], v[72:75], v[34:49]
    v_mfma_f32_32x32x16_bf16 v[18:33], v[2:5], v[72:75], v[18:33]
    ds_read_b64_tr_b16 v[2:3], v54 offset:7168
    ds_read_b64_tr_b16 v[4:5], v54 offset:8192
    ds_read_b64_tr_b16 v[6:7], v55 offset:7168
    ds_read_b64_tr_b16 v[8:9], v55 offset:8192
    s_waitcnt vmcnt(12) lgkmcnt(4)
    v_mfma_f32_32x32x16_bf16 v[34:49], v[14:17], v[76:79], v[34:49]
    v_mfma_f32_32x32x16_bf16 v[18:33], v[10:13], v[76:79], v[18:33]
    ds_read_b64_tr_b16 v[10:11], v54 offset:9216
    ds_read_b64_tr_b16 v[12:13], v54 offset:10240
    ds_read_b64_tr_b16 v[14:15], v55 offset:9216
    ds_read_b64_tr_b16 v[16:17], v55 offset:10240
    s_waitcnt vmcnt(11) lgkmcnt(4)
    v_mfma_f32_32x32x16_bf16 v[34:49], v[6:9], v[80:83], v[34:49]
    v_mfma_f32_32x32x16_bf16 v[18:33], v[2:5], v[80:83], v[18:33]
    ds_read_b64_tr_b16 v[2:3], v54 offset:10752
    ds_read_b64_tr_b16 v[4:5], v54 offset:11776
    ds_read_b64_tr_b16 v[6:7], v55 offset:10752
    ds_read_b64_tr_b16 v[8:9], v55 offset:11776
    s_waitcnt vmcnt(10) lgkmcnt(4)
    v_mfma_f32_32x32x16_bf16 v[34:49], v[14:17], v[84:87], v[34:49]
    v_mfma_f32_32x32x16_bf16 v[18:33], v[10:13], v[84:87], v[18:33]
    ds_read_b64_tr_b16 v[10:11], v54 offset:12800
    ds_read_b64_tr_b16 v[12:13], v54 offset:13824
    ds_read_b64_tr_b16 v[14:15], v55 offset:12800
    ds_read_b64_tr_b16 v[16:17], v55 offset:13824
    s_waitcnt vmcnt(9) lgkmcnt(4)
    v_mfma_f32_32x32x16_bf16 v[34:49], v[6:9], v[88:91], v[34:49]
    v_mfma_f32_32x32x16_bf16 v[18:33], v[2:5], v[88:91], v[18:33]
    ds_read_b64_tr_b16 v[2:3], v54 offset:14336
    ds_read_b64_tr_b16 v[4:5], v54 offset:15360
    ds_read_b64_tr_b16 v[6:7], v55 offset:14336
    ds_read_b64_tr_b16 v[8:9], v55 offset:15360
    s_waitcnt vmcnt(8) lgkmcnt(4)
    v_mfma_f32_32x32x16_bf16 v[34:49], v[14:17], v[92:95], v[34:49]
    v_mfma_f32_32x32x16_bf16 v[18:33], v[10:13], v[92:95], v[18:33]
    ds_read_b64_tr_b16 v[10:11], v54 offset:16384
    ds_read_b64_tr_b16 v[12:13], v54 offset:17408
    ds_read_b64_tr_b16 v[14:15], v55 offset:16384
    ds_read_b64_tr_b16 v[16:17], v55 offset:17408
    s_waitcnt vmcnt(7) lgkmcnt(4)
    v_mfma_f32_32x32x16_bf16 v[34:49], v[6:9], v[96:99], v[34:49]
    v_mfma_f32_32x32x16_bf16 v[18:33], v[2:5], v[96:99], v[18:33]
    ds_read_b64_tr_b16 v[2:3], v54 offset:17920
    ds_read_b64_tr_b16 v[4:5], v54 offset:18944
    ds_read_b64_tr_b16 v[6:7], v55 offset:17920
    ds_read_b64_tr_b16 v[8:9], v55 offset:18944
    s_waitcnt vmcnt(6) lgkmcnt(4)
    v_mfma_f32_32x32x16_bf16 v[34:49], v[14:17], v[100:103], v[34:49]
    v_mfma_f32_32x32x16_bf16 v[18:33], v[10:13], v[100:103], v[18:33]
    ds_read_b64_tr_b16 v[10:11], v54 offset:19968
    ds_read_b64_tr_b16 v[12:13], v54 offset:20992
    ds_read_b64_tr_b16 v[14:15], v55 offset:19968
    ds_read_b64_tr_b16 v[16:17], v55 offset:20992
    s_waitcnt vmcnt(5) lgkmcnt(4)
    v_mfma_f32_32x32x16_bf16 v[34:49], v[6:9], v[104:107], v[34:49]
    v_mfma_f32_32x32x16_bf16 v[18:33], v[2:5], v[104:107], v[18:33]
    ds_read_b64_tr_b16 v[2:3], v54 offset:21504
    ds_read_b64_tr_b16 v[4:5], v54 offset:22528
    ds_read_b64_tr_b16 v[6:7], v55 offset:21504
    ds_read_b64_tr_b16 v[8:9], v55 offset:22528
    s_waitcnt vmcnt(4) lgkmcnt(4)
    v_mfma_f32_32x32x16_bf16 v[34:49], v[14:17], v[108:111], v[34:49]
    v_mfma_f32_32x32x16_bf16 v[18:33], v[10:13], v[108:111], v[18:33]
    ds_read_b64_tr_b16 v[10:11], v54 offset:23552
    ds_read_b64_tr_b16 v[12:13], v54 offset:24576
    ds_read_b64_tr_b16 v[14:15], v55 offset:23552
    ds_read_b64_tr_b16 v[16:17], v55 offset:24576
    s_waitcnt vmcnt(3) lgkmcnt(4)
    v_mfma_f32_32x32x16_bf16 v[34:49], v[6:9], v[112:115], v[34:49]
    v_mfma_f32_32x32x16_bf16 v[18:33], v[2:5], v[112:115], v[18:33]
    ds_read_b64_tr_b16 v[2:3], v54 offset:25088
    ds_read_b64_tr_b16 v[4:5], v54 offset:26112
    ds_read_b64_tr_b16 v[6:7], v55 offset:25088
    ds_read_b64_tr_b16 v[8:9], v55 offset:26112
    s_waitcnt vmcnt(2) lgkmcnt(4)
    v_mfma_f32_32x32x16_bf16 v[34:49], v[14:17], v[116:119], v[34:49]
    v_mfma_f32_32x32x16_bf16 v[18:33], v[10:13], v[116:119], v[18:33]
    ds_read_b64_tr_b16 v[10:11], v54 offset:27136
    ds_read_b64_tr_b16 v[12:13], v54 offset:28160
    ds_read_b64_tr_b16 v[14:15], v55 offset:27136
    ds_read_b64_tr_b16 v[16:17], v55 offset:28160
    s_waitcnt vmcnt(1) lgkmcnt(4)
    v_mfma_f32_32x32x16_bf16 v[34:49], v[6:9], v[120:123], v[34:49]
    v_mfma_f32_32x32x16_bf16 v[18:33], v[2:5], v[120:123], v[18:33]
    s_waitcnt vmcnt(0) lgkmcnt(0)
    v_mfma_f32_32x32x16_bf16 v[34:49], v[14:17], v[124:127], v[34:49]
    v_mfma_f32_32x32x16_bf16 v[18:33], v[10:13], v[124:127], v[18:33]
    s_nop 10
    ds_write_b128 v62, v[34:37] offset:0
    ds_write_b128 v62, v[38:41] offset:1024
    ds_write_b128 v62, v[42:45] offset:2048
    ds_write_b128 v62, v[46:49] offset:3072
    s_waitcnt lgkmcnt(0)
    s_barrier
    ds_read_b128 v[34:37], v63 offset:0
    ds_read_b128 v[38:41], v63 offset:1024
    ds_read_b128 v[42:45], v63 offset:2048
    ds_read_b128 v[46:49], v63 offset:3072
    s_waitcnt lgkmcnt(3)
    v_pk_add_f32 v[18:19], v[18:19], v[34:35]
    v_cvt_pk_bf16_f32 v2, v18, v19
    v_pk_add_f32 v[20:21], v[20:21], v[36:37]
    v_cvt_pk_bf16_f32 v3, v20, v21
    s_waitcnt lgkmcnt(2)
    v_pk_add_f32 v[22:23], v[22:23], v[38:39]
    v_cvt_pk_bf16_f32 v4, v22, v23
    v_pk_add_f32 v[24:25], v[24:25], v[40:41]
    v_cvt_pk_bf16_f32 v5, v24, v25
    s_waitcnt lgkmcnt(1)
    v_pk_add_f32 v[26:27], v[26:27], v[42:43]
    v_cvt_pk_bf16_f32 v6, v26, v27
    v_pk_add_f32 v[28:29], v[28:29], v[44:45]
    v_cvt_pk_bf16_f32 v7, v28, v29
    s_waitcnt lgkmcnt(0)
    v_pk_add_f32 v[30:31], v[30:31], v[46:47]
    v_cvt_pk_bf16_f32 v8, v30, v31
    v_pk_add_f32 v[32:33], v[32:33], v[48:49]
    v_cvt_pk_bf16_f32 v9, v32, v33
    v_permlane32_swap_b32 v2, v4
    v_permlane32_swap_b32 v3, v5
    v_permlane32_swap_b32 v6, v8
    v_permlane32_swap_b32 v7, v9
    buffer_store_dwordx4 v[2:5], v58, s[40:43], s60 offen
    buffer_store_dwordx4 v[6:9], v59, s[40:43], s60 offen
    s_branch b_exit
b_pref:
    s_endpgm
    s_mov_b32 s28, s12
    s_mov_b32 s29, s13
    s_mov_b32 s30, 7340032
    s_mov_b32 s31, 0x20000
    s_bfe_u32 s53, s2, 0x20001
    s_mul_i32 s53, s53, 896
    s_lshr_b32 s54, s2, 3
    s_mul_i32 s54, s54, 28672
    s_add_u32 s49, s53, s54
    v_mul_u32_u24 v2, 9363, v1
    v_lshrrev_b32 v2, 16, v2
    v_mul_u32_u24 v3, 7, v2
    v_sub_u32 v3, v1, v3
    v_mul_u32_u24 v2, 3584, v2
    v_lshl_add_u32 v2, v3, 7, v2
    s_mov_b32 exec_hi, 0xffffff
    buffer_load_dword v4, v2, s[28:31], s49 offen
    s_add_u32 s49, s49, 917504
    s_waitcnt vmcnt(0)
    buffer_load_dword v4, v2, s[28:31], s49 offen
    s_add_u32 s49, s49, 917504
    s_lshr_b32 s54, s2, 3
    s_and_b32 s53, s2, 1
    s_mul_i32 s52, s53, 25
    s_add_u32 s52, s52, s54
    s_mul_i32 s51, s52, 9363
    s_lshr_b32 s51, s51, 16
    s_mul_i32 s50, s51, 7
    s_sub_u32 s52, s52, s50
    s_bfe_u32 s50, s2, 0x20001
    s_mul_i32 s50, s50, 7
    s_add_u32 s50, s50, s52
    s_add_u32 s54, s54, s53
    s_cmp_ge_u32 s54, 25
    s_cbranch_scc1 b_pref1
    s_barrier
b_pref1:
    s_waitcnt vmcnt(0)
    buffer_load_dword v4, v2, s[28:31], s49 offen
    s_add_u32 s49, s49, 917504
    s_waitcnt vmcnt(0)
    buffer_load_dword v4, v2, s[28:31], s49 offen
    s_add_u32 s49, s49, 917504
    s_waitcnt vmcnt(0)
    buffer_load_dword v4, v2, s[28:31], s49 offen
    s_add_u32 s49, s49, 917504
    s_waitcnt vmcnt(0)
    buffer_load_dword v4, v2, s[28:31], s49 offen
    s_add_u32 s49, s49, 917504
    s_waitcnt vmcnt(0)
    buffer_load_dword v4, v2, s[28:31], s49 offen
    s_add_u32 s49, s49, 917504
    s_waitcnt vmcnt(0)
    buffer_load_dword v4, v2, s[28:31], s49 offen
    s_add_u32 s49, s49, 917504
    s_endpgm
b_help:
    s_setprio 3
    s_and_b32 s48, s2, 7
    s_lshl_b32 s48, s48, 7
    s_add_u32 s48, s48, 12713984
    s_cmp_lt_u32 s2, 248
    s_cbranch_scc1 b_h1
    v_lshlrev_b32 v2, 7, v1
    s_mov_b32 s44, 12582912
    s_mov_b32 s49, 12591104
    s_mov_b32 s45, 200000
b_wh:
    buffer_load_dword v42, v2, s[36:39], s44 offen sc1
    buffer_load_dword v43, v2, s[36:39], s49 offen sc1
    s_waitcnt vmcnt(0)
    v_xor_b32 v42, v42, v40
    v_xor_b32 v43, v43, v40
    v_or_b32 v42, v42, v43
    v_cmp_ne_u32 vcc, 0, v42
    s_and_b64 exec, exec, vcc
    s_cbranch_execz b_wh_ok
    s_sleep 2
    s_sub_u32 s45, s45, 1
    s_cbranch_scc0 b_wh
b_wh_ok:
    s_mov_b64 exec, -1
    v_lshlrev_b32 v41, 2, v1
    s_mov_b32 exec_hi, 0
    buffer_store_dword v40, v41, s[36:39], s48 offen sc1
    s_mov_b32 exec_hi, -1
b_h1:
    s_lshr_b32 s53, s2, 4
    s_cmp_lg_u32 s53, 14
    s_cbranch_scc1 b_h1b
    s_and_b32 s54, s2, 7
    s_lshl_b32 s54, s54, 1
    s_bfe_u32 s53, s2, 0x10003
    s_add_u32 s54, s54, s53
    s_lshl_b32 s49, s54, 7
    s_add_u32 s49, s49, 12716032
    v_lshrrev_b32 v3, 4, v1
    v_add_u32 v3, 1, v3
    v_lshlrev_b32 v3, 4, v3
    v_add_u32 v3, s54, v3
    v_mul_u32_u24 v3, 0x5556, v3
    v_lshrrev_b32 v3, 16, v3
    v_and_b32 v2, 15, v1
    v_lshl_add_u32 v2, v3, 4, v2
    v_lshlrev_b32 v2, 7, v2
    s_mov_b32 s44, 12615680
    s_mov_b32 exec_hi, 0
    s_mov_b32 s45, 200000
b_wkv:
    buffer_load_dword v42, v2, s[36:39], s44 offen sc1
    s_waitcnt vmcnt(0)
    v_cmp_ne_u32 vcc, v42, v40
    s_and_b64 exec, exec, vcc
    s_cbranch_execz b_wkv_ok
    s_sleep 2
    s_sub_u32 s45, s45, 1
    s_cbranch_scc0 b_wkv
b_wkv_ok:
    s_mov_b64 exec, -1
    v_lshlrev_b32 v41, 2, v1
    s_mov_b32 exec_hi, 0
    buffer_store_dword v40, v41, s[36:39], s49 offen sc1
    s_mov_b32 exec_hi, -1
b_h1b:
    s_lshr_b32 s54, s2, 3
    s_and_b32 s53, s2, 1
    s_mul_i32 s52, s53, 25
    s_add_u32 s52, s52, s54
    s_mul_i32 s51, s52, 9363
    s_lshr_b32 s51, s51, 16
    s_mul_i32 s50, s51, 7
    s_sub_u32 s52, s52, s50
    s_bfe_u32 s50, s2, 0x20001
    s_mul_i32 s50, s50, 7
    s_add_u32 s50, s50, s52
    s_add_u32 s54, s54, s53
    s_cmp_ge_u32 s54, 25
    s_cbranch_scc1 b_h2
    v_mov_b32 v2, 0
    s_mov_b64 exec, 1
    s_mov_b32 s45, 200000
b_wa:
    buffer_load_dword v42, v2, s[36:39], s48 offen sc1
    s_waitcnt vmcnt(0)
    v_cmp_ne_u32 vcc, v42, v40
    s_and_b64 exec, exec, vcc
    s_cbranch_execz b_wa_ok
    s_sleep 3
    s_sub_u32 s45, s45, 1
    s_cbranch_scc0 b_wa
b_wa_ok:
    s_mov_b64 exec, -1
    s_barrier
    s_lshl_b32 s44, s51, 5
    s_add_u32 s44, s44, s50
    s_lshl_b32 s44, s44, 7
    s_add_u32 s44, s44, 12648448
    s_mov_b32 s28, s16
    s_mov_b32 s29, s17
    s_mov_b32 s30, 7340032
    s_mov_b32 s31, 0x20000
    s_mov_b32 s32, s8
    s_mov_b32 s33, s9
    s_mov_b32 s34, 401408
    s_mov_b32 s35, 0x20000
    s_lshr_b32 s53, s2, 3
    s_mul_i32 s54, s53, 80
    s_and_b32 s55, s2, 1
    s_add_u32 s54, s54, s55
    s_lshl_b32 s54, s54, 12
    s_bfe_u32 s55, s2, 0x20001
    s_lshl_b32 s55, s55, 10
    s_add_u32 s54, s54, s55
    s_lshl_b32 s53, s53, 3
    s_and_b32 s55, s2, 7
    s_add_u32 s53, s53, s55
    s_mul_i32 s53, s53, 2176
    v_lshrrev_b32 v3, 3, v1
    v_lshlrev_b32 v3, 13, v3
    v_and_b32 v4, 7, v1
    v_lshl_add_u32 v3, v4, 7, v3
    v_min_u32 v4, 16, v1
    v_lshlrev_b32 v4, 7, v4
    s_barrier
    buffer_load_dword v5, v3, s[28:31], s54 offen
    s_add_u32 s54, s54, 65536
    buffer_load_dword v5, v3, s[28:31], s54 offen
    s_add_u32 s54, s54, 65536
    buffer_load_dword v5, v3, s[28:31], s54 offen
    s_add_u32 s54, s54, 65536
    buffer_load_dword v5, v3, s[28:31], s54 offen
    s_add_u32 s54, s54, 65536
    buffer_load_dword v5, v3, s[28:31], s54 offen
    s_add_u32 s54, s54, 65536
    buffer_load_dword v5, v4, s[32:35], s53 offen
    s_barrier
    s_barrier
    v_lshlrev_b32 v41, 2, v1
    s_mov_b32 exec_hi, 0
    buffer_store_dword v40, v41, s[36:39], s44 offen sc1
    s_mov_b32 exec_hi, -1
b_h2:
    s_lshr_b32 s54, s2, 3
    s_and_b32 s53, s2, 1
    s_mul_i32 s53, s53, 28
    s_add_u32 s53, s53, s54
    s_lshr_b32 s51, s53, 3
    s_and_b32 s53, s53, 7
    s_bfe_u32 s50, s2, 0x20001
    s_lshl_b32 s50, s50, 3
    s_add_u32 s50, s50, s53
    s_cmp_ge_u32 s54, 28
    s_cbranch_scc1 b_exit
    v_lshlrev_b32 v2, 7, v1
    s_lshl_b32 s44, s51, 12
    s_add_u32 s44, s44, 12648448
    s_mov_b64 exec, 0xfffffff
    s_mov_b32 s45, 200000
b_wu:
    buffer_load_dword v42, v2, s[36:39], s44 offen sc1
    s_waitcnt vmcnt(0)
    v_cmp_ne_u32 vcc, v42, v40
    s_and_b64 exec, exec, vcc
    s_cbranch_execz b_wu_ok
    s_sleep 3
    s_sub_u32 s45, s45, 1
    s_cbranch_scc0 b_wu
b_wu_ok:
    s_mov_b64 exec, -1
    s_barrier
    s_lshr_b32 s44, s50, 1
    s_lshl_b32 s44, s44, 11
    s_add_u32 s44, s44, 12681216
    s_barrier
    s_barrier
    s_mov_b64 exec, 0xffff
    s_mov_b32 s45, 200000
b_wo:
    buffer_load_dword v42, v2, s[36:39], s44 offen sc1
    s_waitcnt vmcnt(0)
    v_cmp_ne_u32 vcc, v42, v40
    s_and_b64 exec, exec, vcc
    s_cbranch_execz b_wo_ok
    s_sleep 3
    s_sub_u32 s45, s45, 1
    s_cbranch_scc0 b_wo
b_wo_ok:
    s_mov_b64 exec, -1
    s_barrier
b_exit:
exit0:
    s_endpgm
a_comp2:
    v_and_b32 v2, 31, v1
    v_lshrrev_b32 v3, 5, v1
    v_bfe_u32 v4, v1, 1, 3
    v_xor_b32 v4, v4, v3
    v_lshlrev_b32 v4, 4, v4
    v_lshl_add_u32 v4, v2, 7, v4
    v_add_u32 v4, s51, v4
    v_bfe_u32 v5, v1, 2, 2
    v_lshl_add_u32 v5, v3, 3, v5
    v_mul_u32_u24 v5, 192, v5
    v_bfe_u32 v6, v1, 4, 1
    v_lshl_add_u32 v5, v6, 5, v5
    v_and_b32 v6, 3, v1
    v_lshl_add_u32 v5, v6, 3, v5
    v_add_u32 v5, 32768, v5
    s_add_u32 s53, s26, 0
    s_and_b32 s53, s53, 3
    s_lshl_b32 s54, s53, 5
    s_mul_i32 s53, s53, 3072
    v_xor_b32 v49, s54, v4
    v_add_u32 v53, s53, v5
    s_add_u32 s53, s26, 1
    s_and_b32 s53, s53, 3
    s_lshl_b32 s54, s53, 5
    s_mul_i32 s53, s53, 3072
    v_xor_b32 v50, s54, v4
    v_add_u32 v54, s53, v5
    s_add_u32 s53, s26, 2
    s_and_b32 s53, s53, 3
    s_lshl_b32 s54, s53, 5
    s_mul_i32 s53, s53, 3072
    v_xor_b32 v51, s54, v4
    v_add_u32 v55, s53, v5
    s_add_u32 s53, s26, 3
    s_and_b32 s53, s53, 3
    s_lshl_b32 s54, s53, 5
    s_mul_i32 s53, s53, 3072
    v_xor_b32 v52, s54, v4
    v_add_u32 v56, s53, v5
    v_mov_b32 v62, 0x3f803f80
    s_mul_i32 s53, s48, 3
    s_add_u32 s53, s53, 0
    s_and_b32 s54, s53, 15
    s_lshl_b32 s54, s54, 6
    s_add_u32 s54, s54, s57
    s_lshl_b32 s55, s54, 11
    s_lshl_b32 s54, s54, 12
    s_add_u32 s54, s54, 2097152
    s_cmp_ge_u32 s53, 32
    s_cselect_b32 s56, 2048, 0
    s_add_u32 s54, s54, s56
    s_cmp_lt_u32 s53, 16
    s_cselect_b32 s58, s55, s54
    s_cselect_b32 s61, 0x3e8b97f6, 1.0
    s_mul_i32 s53, s48, 3
    s_add_u32 s53, s53, 1
    s_and_b32 s54, s53, 15
    s_lshl_b32 s54, s54, 6
    s_add_u32 s54, s54, s57
    s_lshl_b32 s55, s54, 11
    s_lshl_b32 s54, s54, 12
    s_add_u32 s54, s54, 2097152
    s_cmp_ge_u32 s53, 32
    s_cselect_b32 s56, 2048, 0
    s_add_u32 s54, s54, s56
    s_cmp_lt_u32 s53, 16
    s_cselect_b32 s59, s55, s54
    s_cselect_b32 s62, 0x3e8b97f6, 1.0
    s_mul_i32 s53, s48, 3
    s_add_u32 s53, s53, 2
    s_and_b32 s54, s53, 15
    s_lshl_b32 s54, s54, 6
    s_add_u32 s54, s54, s57
    s_lshl_b32 s55, s54, 11
    s_lshl_b32 s54, s54, 12
    s_add_u32 s54, s54, 2097152
    s_cmp_ge_u32 s53, 32
    s_cselect_b32 s56, 2048, 0
    s_add_u32 s54, s54, s56
    s_cmp_lt_u32 s53, 16
    s_cselect_b32 s60, s55, s54
    s_cselect_b32 s63, 0x3e8b97f6, 1.0
    s_cmp_ge_u32 s48, 11
    s_cbranch_scc1 qkv_vvv
    s_cmp_eq_u32 s48, 10
    s_cbranch_scc1 qkv_nnv
    s_waitcnt vmcnt(4) lgkmcnt(0)
    s_barrier
    ds_read_b128 v[2:5], v49 offset:0
    ds_read_b128 v[6:9], v50 offset:0
    ds_read_b128 v[10:13], v51 offset:0
    ds_read_b128 v[14:17], v52 offset:0
    ds_read_b64_tr_b16 v[18:19], v53 offset:0
    ds_read_b64_tr_b16 v[20:21], v53 offset:768
    ds_read_b64_tr_b16 v[22:23], v53 offset:56
    ds_read_b64_tr_b16 v[24:25], v53 offset:824
    ds_read_b64_tr_b16 v[26:27], v53 offset:112
    ds_read_b64_tr_b16 v[28:29], v53 offset:880
    s_waitcnt lgkmcnt(4)
    v_mfma_f32_32x32x16_bf16 v[64:79], v[18:21], v[2:5], 0
    ds_read_b64_tr_b16 v[30:31], v54 offset:0
    ds_read_b64_tr_b16 v[32:33], v54 offset:768
    s_waitcnt lgkmcnt(4)
    v_mfma_f32_32x32x16_bf16 v[80:95], v[22:25], v[2:5], 0
    ds_read_b64_tr_b16 v[34:35], v54 offset:56
    ds_read_b64_tr_b16 v[36:37], v54 offset:824
    s_add_u32 m0, s51, 0
    s_nop 0
    buffer_load_dwordx4 v42, s[28:31], s49 offen offset:0 lds
    s_waitcnt lgkmcnt(4)
    v_mfma_f32_32x32x16_bf16 v[96:111], v[26:29], v[2:5], 0
    ds_read_b64_tr_b16 v[38:39], v54 offset:112
    ds_read_b64_tr_b16 v[40:41], v54 offset:880
    s_waitcnt lgkmcnt(4)
    v_mfma_f32_32x32x16_bf16 v[64:79], v[30:33], v[6:9], v[64:79]
    ds_read_b64_tr_b16 v[18:19], v55 offset:0
    ds_read_b64_tr_b16 v[20:21], v55 offset:768
    buffer_load_dwordx4 v43, s[28:31], s49 offen offset:1024 lds
    s_waitcnt lgkmcnt(4)
    v_mfma_f32_32x32x16_bf16 v[80:95], v[34:37], v[6:9], v[80:95]
    ds_read_b64_tr_b16 v[22:23], v55 offset:56
    ds_read_b64_tr_b16 v[24:25], v55 offset:824
    s_waitcnt lgkmcnt(4)
    v_mfma_f32_32x32x16_bf16 v[96:111], v[38:41], v[6:9], v[96:111]
    ds_read_b64_tr_b16 v[26:27], v55 offset:112
    ds_read_b64_tr_b16 v[28:29], v55 offset:880
    buffer_load_dwordx4 v44, s[28:31], s49 offen offset:2048 lds
    s_waitcnt lgkmcnt(4)
    v_mfma_f32_32x32x16_bf16 v[64:79], v[18:21], v[10:13], v[64:79]
    ds_read_b64_tr_b16 v[30:31], v56 offset:0
    ds_read_b64_tr_b16 v[32:33], v56 offset:768
    s_waitcnt lgkmcnt(4)
    v_mfma_f32_32x32x16_bf16 v[80:95], v[22:25], v[10:13], v[80:95]
    ds_read_b64_tr_b16 v[34:35], v56 offset:56
    ds_read_b64_tr_b16 v[36:37], v56 offset:824
    buffer_load_dwordx4 v45, s[28:31], s49 offen offset:3072 lds
    s_add_u32 s49, s49, 128
    s_waitcnt lgkmcnt(4)
    v_mfma_f32_32x32x16_bf16 v[96:111], v[26:29], v[10:13], v[96:111]
    ds_read_b64_tr_b16 v[38:39], v56 offset:112
    ds_read_b64_tr_b16 v[40:41], v56 offset:880
    s_waitcnt lgkmcnt(4)
    v_mfma_f32_32x32x16_bf16 v[64:79], v[30:33], v[14:17], v[64:79]
    s_waitcnt lgkmcnt(2)
    v_mfma_f32_32x32x16_bf16 v[80:95], v[34:37], v[14:17], v[80:95]
    s_waitcnt vmcnt(4) lgkmcnt(0)
    s_barrier
    ds_read_b128 v[112:115], v49 offset:16384
    ds_read_b64_tr_b16 v[18:19], v53 offset:12288
    ds_read_b64_tr_b16 v[20:21], v53 offset:13056
    v_mfma_f32_32x32x16_bf16 v[96:111], v[38:41], v[14:17], v[96:111]
    ds_read_b128 v[116:119], v50 offset:16384
    ds_read_b128 v[120:123], v51 offset:16384
    ds_read_b128 v[124:127], v52 offset:16384
    ds_read_b64_tr_b16 v[22:23], v53 offset:12344
    ds_read_b64_tr_b16 v[24:25], v53 offset:13112
    ds_read_b64_tr_b16 v[26:27], v53 offset:12400
    ds_read_b64_tr_b16 v[28:29], v53 offset:13168
    s_waitcnt lgkmcnt(4)
    v_mfma_f32_32x32x16_bf16 v[64:79], v[18:21], v[112:115], v[64:79]
    ds_read_b64_tr_b16 v[30:31], v54 offset:12288
    ds_read_b64_tr_b16 v[32:33], v54 offset:13056
    s_waitcnt lgkmcnt(4)
    v_mfma_f32_32x32x16_bf16 v[80:95], v[22:25], v[112:115], v[80:95]
    ds_read_b64_tr_b16 v[34:35], v54 offset:12344
    ds_read_b64_tr_b16 v[36:37], v54 offset:13112
    s_add_u32 m0, s51, 16384
    s_nop 0
    buffer_load_dwordx4 v42, s[28:31], s49 offen offset:0 lds
    s_waitcnt lgkmcnt(4)
    v_mfma_f32_32x32x16_bf16 v[96:111], v[26:29], v[112:115], v[96:111]
    ds_read_b64_tr_b16 v[38:39], v54 offset:12400
    ds_read_b64_tr_b16 v[40:41], v54 offset:13168
    s_waitcnt lgkmcnt(4)
    v_mfma_f32_32x32x16_bf16 v[64:79], v[30:33], v[116:119], v[64:79]
    ds_read_b64_tr_b16 v[18:19], v55 offset:12288
    ds_read_b64_tr_b16 v[20:21], v55 offset:13056
    buffer_load_dwordx4 v43, s[28:31], s49 offen offset:1024 lds
    s_waitcnt lgkmcnt(4)
    v_mfma_f32_32x32x16_bf16 v[80:95], v[34:37], v[116:119], v[80:95]
    ds_read_b64_tr_b16 v[22:23], v55 offset:12344
    ds_read_b64_tr_b16 v[24:25], v55 offset:13112
    s_waitcnt lgkmcnt(4)
    v_mfma_f32_32x32x16_bf16 v[96:111], v[38:41], v[116:119], v[96:111]
    ds_read_b64_tr_b16 v[26:27], v55 offset:12400
    ds_read_b64_tr_b16 v[28:29], v55 offset:13168
    buffer_load_dwordx4 v44, s[28:31], s49 offen offset:2048 lds
    s_waitcnt lgkmcnt(4)
    v_mfma_f32_32x32x16_bf16 v[64:79], v[18:21], v[120:123], v[64:79]
    ds_read_b64_tr_b16 v[30:31], v56 offset:12288
    ds_read_b64_tr_b16 v[32:33], v56 offset:13056
    s_waitcnt lgkmcnt(4)
    v_mfma_f32_32x32x16_bf16 v[80:95], v[22:25], v[120:123], v[80:95]
    ds_read_b64_tr_b16 v[34:35], v56 offset:12344
    ds_read_b64_tr_b16 v[36:37], v56 offset:13112
    buffer_load_dwordx4 v45, s[28:31], s49 offen offset:3072 lds
    s_add_u32 s49, s49, 128
    s_waitcnt lgkmcnt(4)
    v_mfma_f32_32x32x16_bf16 v[96:111], v[26:29], v[120:123], v[96:111]
    ds_read_b64_tr_b16 v[38:39], v56 offset:12400
    ds_read_b64_tr_b16 v[40:41], v56 offset:13168
    s_waitcnt lgkmcnt(4)
    v_mfma_f32_32x32x16_bf16 v[64:79], v[30:33], v[124:127], v[64:79]
    s_waitcnt lgkmcnt(2)
    v_mfma_f32_32x32x16_bf16 v[80:95], v[34:37], v[124:127], v[80:95]
    s_waitcnt vmcnt(4) lgkmcnt(0)
    s_barrier
    ds_read_b128 v[2:5], v49 offset:0
    ds_read_b64_tr_b16 v[18:19], v53 offset:24576
    ds_read_b64_tr_b16 v[20:21], v53 offset:25344
    v_mfma_f32_32x32x16_bf16 v[96:111], v[38:41], v[124:127], v[96:111]
    ds_read_b128 v[6:9], v50 offset:0
    ds_read_b128 v[10:13], v51 offset:0
    ds_read_b128 v[14:17], v52 offset:0
    ds_read_b64_tr_b16 v[22:23], v53 offset:24632
    ds_read_b64_tr_b16 v[24:25], v53 offset:25400
    ds_read_b64_tr_b16 v[26:27], v53 offset:24688
    ds_read_b64_tr_b16 v[28:29], v53 offset:25456
    s_waitcnt lgkmcnt(4)
    v_mfma_f32_32x32x16_bf16 v[64:79], v[18:21], v[2:5], v[64:79]
    ds_read_b64_tr_b16 v[30:31], v54 offset:24576
    ds_read_b64_tr_b16 v[32:33], v54 offset:25344
    s_waitcnt lgkmcnt(4)
    v_mfma_f32_32x32x16_bf16 v[80:95], v[22:25], v[2:5], v[80:95]
    ds_read_b64_tr_b16 v[34:35], v54 offset:24632
    ds_read_b64_tr_b16 v[36:37], v54 offset:25400
    s_add_u32 m0, s51, 0
    s_nop 0
    buffer_load_dwordx4 v42, s[28:31], s49 offen offset:0 lds
    s_waitcnt lgkmcnt(4)
    v_mfma_f32_32x32x16_bf16 v[96:111], v[26:29], v[2:5], v[96:111]
    ds_read_b64_tr_b16 v[38:39], v54 offset:24688
    ds_read_b64_tr_b16 v[40:41], v54 offset:25456
    s_waitcnt lgkmcnt(4)
    v_mfma_f32_32x32x16_bf16 v[64:79], v[30:33], v[6:9], v[64:79]
    ds_read_b64_tr_b16 v[18:19], v55 offset:24576
    ds_read_b64_tr_b16 v[20:21], v55 offset:25344
    buffer_load_dwordx4 v43, s[28:31], s49 offen offset:1024 lds
    s_waitcnt lgkmcnt(4)
    v_mfma_f32_32x32x16_bf16 v[80:95], v[34:37], v[6:9], v[80:95]
    ds_read_b64_tr_b16 v[22:23], v55 offset:24632
    ds_read_b64_tr_b16 v[24:25], v55 offset:25400
    s_waitcnt lgkmcnt(4)
    v_mfma_f32_32x32x16_bf16 v[96:111], v[38:41], v[6:9], v[96:111]
    ds_read_b64_tr_b16 v[26:27], v55 offset:24688
    ds_read_b64_tr_b16 v[28:29], v55 offset:25456
    buffer_load_dwordx4 v44, s[28:31], s49 offen offset:2048 lds
    s_waitcnt lgkmcnt(4)
    v_mfma_f32_32x32x16_bf16 v[64:79], v[18:21], v[10:13], v[64:79]
    ds_read_b64_tr_b16 v[30:31], v56 offset:24576
    ds_read_b64_tr_b16 v[32:33], v56 offset:25344
    s_waitcnt lgkmcnt(4)
    v_mfma_f32_32x32x16_bf16 v[80:95], v[22:25], v[10:13], v[80:95]
    ds_read_b64_tr_b16 v[34:35], v56 offset:24632
    ds_read_b64_tr_b16 v[36:37], v56 offset:25400
    buffer_load_dwordx4 v45, s[28:31], s49 offen offset:3072 lds
    s_add_u32 s49, s49, 128
    s_waitcnt lgkmcnt(4)
    v_mfma_f32_32x32x16_bf16 v[96:111], v[26:29], v[10:13], v[96:111]
    ds_read_b64_tr_b16 v[38:39], v56 offset:24688
    ds_read_b64_tr_b16 v[40:41], v56 offset:25456
    s_waitcnt lgkmcnt(4)
    v_mfma_f32_32x32x16_bf16 v[64:79], v[30:33], v[14:17], v[64:79]
    s_waitcnt lgkmcnt(2)
    v_mfma_f32_32x32x16_bf16 v[80:95], v[34:37], v[14:17], v[80:95]
    s_waitcnt vmcnt(4) lgkmcnt(0)
    s_barrier
    ds_read_b128 v[112:115], v49 offset:16384
    ds_read_b64_tr_b16 v[18:19], v53 offset:0
    ds_read_b64_tr_b16 v[20:21], v53 offset:768
    v_mfma_f32_32x32x16_bf16 v[96:111], v[38:41], v[14:17], v[96:111]
    ds_read_b128 v[116:119], v50 offset:16384
    ds_read_b128 v[120:123], v51 offset:16384
    ds_read_b128 v[124:127], v52 offset:16384
    ds_read_b64_tr_b16 v[22:23], v53 offset:56
    ds_read_b64_tr_b16 v[24:25], v53 offset:824
    ds_read_b64_tr_b16 v[26:27], v53 offset:112
    ds_read_b64_tr_b16 v[28:29], v53 offset:880
    s_waitcnt lgkmcnt(4)
    v_mfma_f32_32x32x16_bf16 v[64:79], v[18:21], v[112:115], v[64:79]
    ds_read_b64_tr_b16 v[30:31], v54 offset:0
    ds_read_b64_tr_b16 v[32:33], v54 offset:768
    s_waitcnt lgkmcnt(4)
    v_mfma_f32_32x32x16_bf16 v[80:95], v[22:25], v[112:115], v[80:95]
    ds_read_b64_tr_b16 v[34:35], v54 offset:56
    ds_read_b64_tr_b16 v[36:37], v54 offset:824
    s_add_u32 m0, s51, 16384
    s_nop 0
    buffer_load_dwordx4 v42, s[28:31], s49 offen offset:0 lds
    s_waitcnt lgkmcnt(4)
    v_mfma_f32_32x32x16_bf16 v[96:111], v[26:29], v[112:115], v[96:111]
    ds_read_b64_tr_b16 v[38:39], v54 offset:112
    ds_read_b64_tr_b16 v[40:41], v54 offset:880
    s_waitcnt lgkmcnt(4)
    v_mfma_f32_32x32x16_bf16 v[64:79], v[30:33], v[116:119], v[64:79]
    ds_read_b64_tr_b16 v[18:19], v55 offset:0
    ds_read_b64_tr_b16 v[20:21], v55 offset:768
    buffer_load_dwordx4 v43, s[28:31], s49 offen offset:1024 lds
    s_waitcnt lgkmcnt(4)
    v_mfma_f32_32x32x16_bf16 v[80:95], v[34:37], v[116:119], v[80:95]
    ds_read_b64_tr_b16 v[22:23], v55 offset:56
    ds_read_b64_tr_b16 v[24:25], v55 offset:824
    s_waitcnt lgkmcnt(4)
    v_mfma_f32_32x32x16_bf16 v[96:111], v[38:41], v[116:119], v[96:111]
    ds_read_b64_tr_b16 v[26:27], v55 offset:112
    ds_read_b64_tr_b16 v[28:29], v55 offset:880
    buffer_load_dwordx4 v44, s[28:31], s49 offen offset:2048 lds
    s_waitcnt lgkmcnt(4)
    v_mfma_f32_32x32x16_bf16 v[64:79], v[18:21], v[120:123], v[64:79]
    ds_read_b64_tr_b16 v[30:31], v56 offset:0
    ds_read_b64_tr_b16 v[32:33], v56 offset:768
    s_waitcnt lgkmcnt(4)
    v_mfma_f32_32x32x16_bf16 v[80:95], v[22:25], v[120:123], v[80:95]
    ds_read_b64_tr_b16 v[34:35], v56 offset:56
    ds_read_b64_tr_b16 v[36:37], v56 offset:824
    buffer_load_dwordx4 v45, s[28:31], s49 offen offset:3072 lds
    s_add_u32 s49, s49, 128
    s_waitcnt lgkmcnt(4)
    v_mfma_f32_32x32x16_bf16 v[96:111], v[26:29], v[120:123], v[96:111]
    ds_read_b64_tr_b16 v[38:39], v56 offset:112
    ds_read_b64_tr_b16 v[40:41], v56 offset:880
    s_waitcnt lgkmcnt(4)
    v_mfma_f32_32x32x16_bf16 v[64:79], v[30:33], v[124:127], v[64:79]
    s_waitcnt lgkmcnt(2)
    v_mfma_f32_32x32x16_bf16 v[80:95], v[34:37], v[124:127], v[80:95]
    s_waitcnt vmcnt(4) lgkmcnt(0)
    s_barrier
    ds_read_b128 v[2:5], v49 offset:0
    ds_read_b64_tr_b16 v[18:19], v53 offset:12288
    ds_read_b64_tr_b16 v[20:21], v53 offset:13056
    v_mfma_f32_32x32x16_bf16 v[96:111], v[38:41], v[124:127], v[96:111]
    ds_read_b128 v[6:9], v50 offset:0
    ds_read_b128 v[10:13], v51 offset:0
    ds_read_b128 v[14:17], v52 offset:0
    ds_read_b64_tr_b16 v[22:23], v53 offset:12344
    ds_read_b64_tr_b16 v[24:25], v53 offset:13112
    ds_read_b64_tr_b16 v[26:27], v53 offset:12400
    ds_read_b64_tr_b16 v[28:29], v53 offset:13168
    s_waitcnt lgkmcnt(4)
    v_mfma_f32_32x32x16_bf16 v[64:79], v[18:21], v[2:5], v[64:79]
    ds_read_b64_tr_b16 v[30:31], v54 offset:12288
    ds_read_b64_tr_b16 v[32:33], v54 offset:13056
    s_waitcnt lgkmcnt(4)
    v_mfma_f32_32x32x16_bf16 v[80:95], v[22:25], v[2:5], v[80:95]
    ds_read_b64_tr_b16 v[34:35], v54 offset:12344
    ds_read_b64_tr_b16 v[36:37], v54 offset:13112
    s_add_u32 m0, s51, 0
    s_nop 0
    buffer_load_dwordx4 v42, s[28:31], s49 offen offset:0 lds
    s_waitcnt lgkmcnt(4)
    v_mfma_f32_32x32x16_bf16 v[96:111], v[26:29], v[2:5], v[96:111]
    ds_read_b64_tr_b16 v[38:39], v54 offset:12400
    ds_read_b64_tr_b16 v[40:41], v54 offset:13168
    s_waitcnt lgkmcnt(4)
    v_mfma_f32_32x32x16_bf16 v[64:79], v[30:33], v[6:9], v[64:79]
    ds_read_b64_tr_b16 v[18:19], v55 offset:12288
    ds_read_b64_tr_b16 v[20:21], v55 offset:13056
    buffer_load_dwordx4 v43, s[28:31], s49 offen offset:1024 lds
    s_waitcnt lgkmcnt(4)
    v_mfma_f32_32x32x16_bf16 v[80:95], v[34:37], v[6:9], v[80:95]
    ds_read_b64_tr_b16 v[22:23], v55 offset:12344
    ds_read_b64_tr_b16 v[24:25], v55 offset:13112
    s_waitcnt lgkmcnt(4)
    v_mfma_f32_32x32x16_bf16 v[96:111], v[38:41], v[6:9], v[96:111]
    ds_read_b64_tr_b16 v[26:27], v55 offset:12400
    ds_read_b64_tr_b16 v[28:29], v55 offset:13168
    buffer_load_dwordx4 v44, s[28:31], s49 offen offset:2048 lds
    s_waitcnt lgkmcnt(4)
    v_mfma_f32_32x32x16_bf16 v[64:79], v[18:21], v[10:13], v[64:79]
    ds_read_b64_tr_b16 v[30:31], v56 offset:12288
    ds_read_b64_tr_b16 v[32:33], v56 offset:13056
    s_waitcnt lgkmcnt(4)
    v_mfma_f32_32x32x16_bf16 v[80:95], v[22:25], v[10:13], v[80:95]
    ds_read_b64_tr_b16 v[34:35], v56 offset:12344
    ds_read_b64_tr_b16 v[36:37], v56 offset:13112
    buffer_load_dwordx4 v45, s[28:31], s49 offen offset:3072 lds
    s_add_u32 s49, s49, 128
    s_waitcnt lgkmcnt(4)
    v_mfma_f32_32x32x16_bf16 v[96:111], v[26:29], v[10:13], v[96:111]
    ds_read_b64_tr_b16 v[38:39], v56 offset:12400
    ds_read_b64_tr_b16 v[40:41], v56 offset:13168
    s_waitcnt lgkmcnt(4)
    v_mfma_f32_32x32x16_bf16 v[64:79], v[30:33], v[14:17], v[64:79]
    s_waitcnt lgkmcnt(2)
    v_mfma_f32_32x32x16_bf16 v[80:95], v[34:37], v[14:17], v[80:95]
    s_waitcnt vmcnt(4) lgkmcnt(0)
    s_barrier
    ds_read_b128 v[112:115], v49 offset:16384
    ds_read_b64_tr_b16 v[18:19], v53 offset:24576
    ds_read_b64_tr_b16 v[20:21], v53 offset:25344
    v_mfma_f32_32x32x16_bf16 v[96:111], v[38:41], v[14:17], v[96:111]
    ds_read_b128 v[116:119], v50 offset:16384
    ds_read_b128 v[120:123], v51 offset:16384
    ds_read_b128 v[124:127], v52 offset:16384
    ds_read_b64_tr_b16 v[22:23], v53 offset:24632
    ds_read_b64_tr_b16 v[24:25], v53 offset:25400
    ds_read_b64_tr_b16 v[26:27], v53 offset:24688
    ds_read_b64_tr_b16 v[28:29], v53 offset:25456
    s_waitcnt lgkmcnt(4)
    v_mfma_f32_32x32x16_bf16 v[64:79], v[18:21], v[112:115], v[64:79]
    ds_read_b64_tr_b16 v[30:31], v54 offset:24576
    ds_read_b64_tr_b16 v[32:33], v54 offset:25344
    s_waitcnt lgkmcnt(4)
    v_mfma_f32_32x32x16_bf16 v[80:95], v[22:25], v[112:115], v[80:95]
    ds_read_b64_tr_b16 v[34:35], v54 offset:24632
    ds_read_b64_tr_b16 v[36:37], v54 offset:25400
    s_waitcnt lgkmcnt(4)
    v_mfma_f32_32x32x16_bf16 v[96:111], v[26:29], v[112:115], v[96:111]
    ds_read_b64_tr_b16 v[38:39], v54 offset:24688
    ds_read_b64_tr_b16 v[40:41], v54 offset:25456
    s_waitcnt lgkmcnt(4)
    v_mfma_f32_32x32x16_bf16 v[64:79], v[30:33], v[116:119], v[64:79]
    ds_read_b64_tr_b16 v[18:19], v55 offset:24576
    ds_read_b64_tr_b16 v[20:21], v55 offset:25344
    s_waitcnt lgkmcnt(4)
    v_mfma_f32_32x32x16_bf16 v[80:95], v[34:37], v[116:119], v[80:95]
    ds_read_b64_tr_b16 v[22:23], v55 offset:24632
    ds_read_b64_tr_b16 v[24:25], v55 offset:25400
    s_waitcnt lgkmcnt(4)
    v_mfma_f32_32x32x16_bf16 v[96:111], v[38:41], v[116:119], v[96:111]
    ds_read_b64_tr_b16 v[26:27], v55 offset:24688
    ds_read_b64_tr_b16 v[28:29], v55 offset:25456
    s_waitcnt lgkmcnt(4)
    v_mfma_f32_32x32x16_bf16 v[64:79], v[18:21], v[120:123], v[64:79]
    ds_read_b64_tr_b16 v[30:31], v56 offset:24576
    ds_read_b64_tr_b16 v[32:33], v56 offset:25344
    s_waitcnt lgkmcnt(4)
    v_mfma_f32_32x32x16_bf16 v[80:95], v[22:25], v[120:123], v[80:95]
    ds_read_b64_tr_b16 v[34:35], v56 offset:24632
    ds_read_b64_tr_b16 v[36:37], v56 offset:25400
    s_waitcnt lgkmcnt(4)
    v_mfma_f32_32x32x16_bf16 v[96:111], v[26:29], v[120:123], v[96:111]
    ds_read_b64_tr_b16 v[38:39], v56 offset:24688
    ds_read_b64_tr_b16 v[40:41], v56 offset:25456
    s_waitcnt lgkmcnt(4)
    v_mfma_f32_32x32x16_bf16 v[64:79], v[30:33], v[124:127], v[64:79]
    s_waitcnt lgkmcnt(2)
    v_mfma_f32_32x32x16_bf16 v[80:95], v[34:37], v[124:127], v[80:95]
    s_waitcnt vmcnt(0) lgkmcnt(0)
    s_barrier
    ds_read_b128 v[2:5], v49 offset:0
    ds_read_b64_tr_b16 v[18:19], v53 offset:0
    ds_read_b64_tr_b16 v[20:21], v53 offset:768
    v_mfma_f32_32x32x16_bf16 v[96:111], v[38:41], v[124:127], v[96:111]
    ds_read_b128 v[6:9], v50 offset:0
    ds_read_b128 v[10:13], v51 offset:0
    ds_read_b128 v[14:17], v52 offset:0
    ds_read_b64_tr_b16 v[22:23], v53 offset:56
    ds_read_b64_tr_b16 v[24:25], v53 offset:824
    ds_read_b64_tr_b16 v[26:27], v53 offset:112
    ds_read_b64_tr_b16 v[28:29], v53 offset:880
    s_waitcnt lgkmcnt(4)
    v_mfma_f32_32x32x16_bf16 v[64:79], v[18:21], v[2:5], v[64:79]
    ds_read_b64_tr_b16 v[30:31], v54 offset:0
    ds_read_b64_tr_b16 v[32:33], v54 offset:768
    v_and_b32 v46, 31, v1
    s_lshl_b32 s54, s26, 8
    s_add_u32 s54, s54, 76288
    s_waitcnt lgkmcnt(4)
    v_mfma_f32_32x32x16_bf16 v[80:95], v[22:25], v[2:5], v[80:95]
    ds_read_b64_tr_b16 v[34:35], v54 offset:56
    ds_read_b64_tr_b16 v[36:37], v54 offset:824
    v_lshrrev_b32 v47, 5, v1
    v_lshl_add_u32 v48, v47, 4, s54
    v_lshlrev_b32 v47, 4, v47
    s_waitcnt lgkmcnt(4)
    v_mfma_f32_32x32x16_bf16 v[96:111], v[26:29], v[2:5], v[96:111]
    ds_read_b64_tr_b16 v[38:39], v54 offset:112
    ds_read_b64_tr_b16 v[40:41], v54 offset:880
    v_add_u32 v47, 75776, v47
    v_bfe_u32 v57, v1, 4, 1
    v_mul_u32_u24 v57, 64, v57
    s_waitcnt lgkmcnt(4)
    v_mfma_f32_32x32x16_bf16 v[64:79], v[30:33], v[6:9], v[64:79]
    ds_read_b64_tr_b16 v[18:19], v55 offset:0
    ds_read_b64_tr_b16 v[20:21], v55 offset:768
    v_lshl_add_u32 v57, v46, 2, v57
    v_add_u32 v57, s54, v57
    v_lshlrev_b32 v46, 2, v46
    s_waitcnt lgkmcnt(4)
    v_mfma_f32_32x32x16_bf16 v[80:95], v[34:37], v[6:9], v[80:95]
    ds_read_b64_tr_b16 v[22:23], v55 offset:56
    ds_read_b64_tr_b16 v[24:25], v55 offset:824
    v_add_u32 v46, 75776, v46
    v_lshlrev_b32 v63, 4, v1
    v_mov_b32 v60, 1.0
    s_waitcnt lgkmcnt(4)
    v_mfma_f32_32x32x16_bf16 v[96:111], v[38:41], v[6:9], v[96:111]
    ds_read_b64_tr_b16 v[26:27], v55 offset:112
    ds_read_b64_tr_b16 v[28:29], v55 offset:880
    s_mov_b32 exec_lo, 0
    v_mov_b32 v60, 0
    s_mov_b32 exec_lo, -1
    s_waitcnt lgkmcnt(4)
    v_mfma_f32_32x32x16_bf16 v[64:79], v[18:21], v[10:13], v[64:79]
    ds_read_b64_tr_b16 v[30:31], v56 offset:0
    ds_read_b64_tr_b16 v[32:33], v56 offset:768
    s_waitcnt lgkmcnt(4)
    v_mfma_f32_32x32x16_bf16 v[80:95], v[22:25], v[10:13], v[80:95]
    ds_read_b64_tr_b16 v[34:35], v56 offset:56
    ds_read_b64_tr_b16 v[36:37], v56 offset:824
    s_waitcnt lgkmcnt(4)
    v_mfma_f32_32x32x16_bf16 v[96:111], v[26:29], v[10:13], v[96:111]
    ds_read_b64_tr_b16 v[38:39], v56 offset:112
    ds_read_b64_tr_b16 v[40:41], v56 offset:880
    s_waitcnt lgkmcnt(0)
    s_barrier
    ds_read2_b32 v[42:43], v57 offset0:0 offset1:16
    ds_read_b128 v[112:115], v47 offset:0
    ds_read_b128 v[116:119], v47 offset:32
    ds_read_b128 v[120:123], v47 offset:64
    ds_read_b128 v[124:127], v47 offset:96
    v_mfma_f32_32x32x16_bf16 v[64:79], v[30:33], v[14:17], v[64:79]
    v_mfma_f32_32x32x16_bf16 v[80:95], v[34:37], v[14:17], v[80:95]
    v_mfma_f32_32x32x16_bf16 v[96:111], v[38:41], v[14:17], v[96:111]
    ds_read_b128 v[2:5], v47 offset:112
    ds_read_b128 v[6:9], v47 offset:144
    ds_read_b128 v[10:13], v47 offset:176
    ds_read_b128 v[14:17], v47 offset:208
    ds_read_b128 v[18:21], v47 offset:224
    ds_read_b128 v[22:25], v47 offset:256
    ds_read_b128 v[26:29], v47 offset:288
    ds_read_b128 v[30:33], v47 offset:320
    s_waitcnt lgkmcnt(8)
    v_mul_f32 v50, s61, v43
    v_mul_f32 v51, s61, v43
    v_mul_f32 v56, s61, v42
    v_mul_f32 v57, s61, v42
    v_mul_f32 v44, v56, v60
    v_mul_f32 v45, v56, v60
    v_mul_f32 v52, v50, v60
    v_mul_f32 v53, v50, v60
    s_waitcnt lgkmcnt(8)
    v_pk_mul_f32 v[64:65], v[64:65], v[56:57]
    v_pk_mul_f32 v[66:67], v[66:67], v[56:57]
    v_pk_mul_f32 v[68:69], v[68:69], v[56:57]
    v_pk_mul_f32 v[70:71], v[70:71], v[56:57]
    v_pk_mul_f32 v[72:73], v[72:73], v[56:57]
    v_pk_mul_f32 v[74:75], v[74:75], v[56:57]
    v_pk_mul_f32 v[76:77], v[76:77], v[44:45]
    v_pk_mul_f32 v[78:79], v[78:79], v[44:45]
    v_pk_fma_f32 v[64:65], v[112:113], v[50:51], v[64:65]
    v_pk_fma_f32 v[66:67], v[114:115], v[50:51], v[66:67]
    v_pk_fma_f32 v[68:69], v[116:117], v[50:51], v[68:69]
    v_pk_fma_f32 v[70:71], v[118:119], v[50:51], v[70:71]
    v_pk_fma_f32 v[72:73], v[120:121], v[50:51], v[72:73]
    v_pk_fma_f32 v[74:75], v[122:123], v[50:51], v[74:75]
    v_pk_fma_f32 v[76:77], v[124:125], v[52:53], v[76:77]
    v_pk_fma_f32 v[78:79], v[126:127], v[52:53], v[78:79]
    v_cvt_pk_bf16_f32 v64, v64, v65
    v_cvt_pk_bf16_f32 v65, v66, v67
    v_cvt_pk_bf16_f32 v66, v68, v69
    v_cvt_pk_bf16_f32 v67, v70, v71
    v_cvt_pk_bf16_f32 v68, v72, v73
    v_cvt_pk_bf16_f32 v69, v74, v75
    v_cvt_pk_bf16_f32 v70, v76, v77
    v_cvt_pk_bf16_f32 v71, v78, v79
    buffer_store_dwordx4 v[64:67], v63, s[36:39], s58 offen sc1
    buffer_store_dwordx4 v[68:71], v63, s[36:39], s58 offen offset:1024 sc1
    v_mul_f32 v50, s62, v43
    v_mul_f32 v51, s62, v43
    v_mul_f32 v56, s62, v42
    v_mul_f32 v57, s62, v42
    v_mul_f32 v44, v56, v60
    v_mul_f32 v45, v56, v60
    v_mul_f32 v52, v50, v60
    v_mul_f32 v53, v50, v60
    s_waitcnt lgkmcnt(4)
    v_pk_mul_f32 v[80:81], v[80:81], v[56:57]
    v_pk_mul_f32 v[82:83], v[82:83], v[56:57]
    v_pk_mul_f32 v[84:85], v[84:85], v[56:57]
    v_pk_mul_f32 v[86:87], v[86:87], v[56:57]
    v_pk_mul_f32 v[88:89], v[88:89], v[56:57]
    v_pk_mul_f32 v[90:91], v[90:91], v[56:57]
    v_pk_mul_f32 v[92:93], v[92:93], v[44:45]
    v_pk_mul_f32 v[94:95], v[94:95], v[44:45]
    v_pk_fma_f32 v[80:81], v[2:3], v[50:51], v[80:81]
    v_pk_fma_f32 v[82:83], v[4:5], v[50:51], v[82:83]
    v_pk_fma_f32 v[84:85], v[6:7], v[50:51], v[84:85]
    v_pk_fma_f32 v[86:87], v[8:9], v[50:51], v[86:87]
    v_pk_fma_f32 v[88:89], v[10:11], v[50:51], v[88:89]
    v_pk_fma_f32 v[90:91], v[12:13], v[50:51], v[90:91]
    v_pk_fma_f32 v[92:93], v[14:15], v[52:53], v[92:93]
    v_pk_fma_f32 v[94:95], v[16:17], v[52:53], v[94:95]
    v_cvt_pk_bf16_f32 v80, v80, v81
    v_cvt_pk_bf16_f32 v81, v82, v83
    v_cvt_pk_bf16_f32 v82, v84, v85
    v_cvt_pk_bf16_f32 v83, v86, v87
    v_cvt_pk_bf16_f32 v84, v88, v89
    v_cvt_pk_bf16_f32 v85, v90, v91
    v_cvt_pk_bf16_f32 v86, v92, v93
    v_cvt_pk_bf16_f32 v87, v94, v95
    buffer_store_dwordx4 v[80:83], v63, s[36:39], s59 offen sc1
    buffer_store_dwordx4 v[84:87], v63, s[36:39], s59 offen offset:1024 sc1
    v_mul_f32 v50, s63, v43
    v_mul_f32 v51, s63, v43
    v_mul_f32 v56, s63, v42
    v_mul_f32 v57, s63, v42
    v_mul_f32 v44, v56, v60
    v_mul_f32 v45, v56, v60
    v_mul_f32 v52, v50, v60
    v_mul_f32 v53, v50, v60
    s_waitcnt lgkmcnt(0)
    v_pk_mul_f32 v[96:97], v[96:97], v[56:57]
    v_pk_mul_f32 v[98:99], v[98:99], v[56:57]
    v_pk_mul_f32 v[100:101], v[100:101], v[56:57]
    v_pk_mul_f32 v[102:103], v[102:103], v[56:57]
    v_pk_mul_f32 v[104:105], v[104:105], v[56:57]
    v_pk_mul_f32 v[106:107], v[106:107], v[56:57]
    v_pk_mul_f32 v[108:109], v[108:109], v[44:45]
    v_pk_mul_f32 v[110:111], v[110:111], v[44:45]
    v_pk_fma_f32 v[96:97], v[18:19], v[50:51], v[96:97]
    v_pk_fma_f32 v[98:99], v[20:21], v[50:51], v[98:99]
    v_pk_fma_f32 v[100:101], v[22:23], v[50:51], v[100:101]
    v_pk_fma_f32 v[102:103], v[24:25], v[50:51], v[102:103]
    v_pk_fma_f32 v[104:105], v[26:27], v[50:51], v[104:105]
    v_pk_fma_f32 v[106:107], v[28:29], v[50:51], v[106:107]
    v_pk_fma_f32 v[108:109], v[30:31], v[52:53], v[108:109]
    v_pk_fma_f32 v[110:111], v[32:33], v[52:53], v[110:111]
    v_cvt_pk_bf16_f32 v96, v96, v97
    v_cvt_pk_bf16_f32 v97, v98, v99
    v_cvt_pk_bf16_f32 v98, v100, v101
    v_cvt_pk_bf16_f32 v99, v102, v103
    v_cvt_pk_bf16_f32 v100, v104, v105
    v_cvt_pk_bf16_f32 v101, v106, v107
    v_cvt_pk_bf16_f32 v102, v108, v109
    v_cvt_pk_bf16_f32 v103, v110, v111
    buffer_store_dwordx4 v[96:99], v63, s[36:39], s60 offen sc1
    buffer_store_dwordx4 v[100:103], v63, s[36:39], s60 offen offset:1024 sc1
    s_branch a_pub
qkv_nnv:
    s_waitcnt vmcnt(4) lgkmcnt(0)
    s_barrier
    ds_read_b128 v[2:5], v49 offset:0
    ds_read_b128 v[6:9], v50 offset:0
    ds_read_b128 v[10:13], v51 offset:0
    ds_read_b128 v[14:17], v52 offset:0
    ds_read_b64_tr_b16 v[18:19], v53 offset:0
    ds_read_b64_tr_b16 v[20:21], v53 offset:768
    ds_read_b64_tr_b16 v[22:23], v53 offset:56
    ds_read_b64_tr_b16 v[24:25], v53 offset:824
    ds_read_b64_tr_b16 v[26:27], v53 offset:112
    ds_read_b64_tr_b16 v[28:29], v53 offset:880
    s_waitcnt lgkmcnt(4)
    v_mfma_f32_32x32x16_bf16 v[64:79], v[18:21], v[2:5], 0
    ds_read_b64_tr_b16 v[30:31], v54 offset:0
    ds_read_b64_tr_b16 v[32:33], v54 offset:768
    s_waitcnt lgkmcnt(4)
    v_mfma_f32_32x32x16_bf16 v[80:95], v[22:25], v[2:5], 0
    ds_read_b64_tr_b16 v[34:35], v54 offset:56
    ds_read_b64_tr_b16 v[36:37], v54 offset:824
    s_add_u32 m0, s51, 0
    s_nop 0
    buffer_load_dwordx4 v42, s[28:31], s49 offen offset:0 lds
    s_waitcnt lgkmcnt(4)
    v_mfma_f32_32x32x16_bf16 v[96:111], v[2:5], v[26:29], 0
    ds_read_b64_tr_b16 v[38:39], v54 offset:112
    ds_read_b64_tr_b16 v[40:41], v54 offset:880
    s_waitcnt lgkmcnt(4)
    v_mfma_f32_32x32x16_bf16 v[64:79], v[30:33], v[6:9], v[64:79]
    ds_read_b64_tr_b16 v[18:19], v55 offset:0
    ds_read_b64_tr_b16 v[20:21], v55 offset:768
    buffer_load_dwordx4 v43, s[28:31], s49 offen offset:1024 lds
    s_waitcnt lgkmcnt(4)
    v_mfma_f32_32x32x16_bf16 v[80:95], v[34:37], v[6:9], v[80:95]
    ds_read_b64_tr_b16 v[22:23], v55 offset:56
    ds_read_b64_tr_b16 v[24:25], v55 offset:824
    s_waitcnt lgkmcnt(4)
    v_mfma_f32_32x32x16_bf16 v[96:111], v[6:9], v[38:41], v[96:111]
    ds_read_b64_tr_b16 v[26:27], v55 offset:112
    ds_read_b64_tr_b16 v[28:29], v55 offset:880
    buffer_load_dwordx4 v44, s[28:31], s49 offen offset:2048 lds
    s_waitcnt lgkmcnt(4)
    v_mfma_f32_32x32x16_bf16 v[64:79], v[18:21], v[10:13], v[64:79]
    ds_read_b64_tr_b16 v[30:31], v56 offset:0
    ds_read_b64_tr_b16 v[32:33], v56 offset:768
    s_waitcnt lgkmcnt(4)
    v_mfma_f32_32x32x16_bf16 v[80:95], v[22:25], v[10:13], v[80:95]
    ds_read_b64_tr_b16 v[34:35], v56 offset:56
    ds_read_b64_tr_b16 v[36:37], v56 offset:824
    buffer_load_dwordx4 v45, s[28:31], s49 offen offset:3072 lds
    s_add_u32 s49, s49, 128
    s_waitcnt lgkmcnt(4)
    v_mfma_f32_32x32x16_bf16 v[96:111], v[10:13], v[26:29], v[96:111]
    ds_read_b64_tr_b16 v[38:39], v56 offset:112
    ds_read_b64_tr_b16 v[40:41], v56 offset:880
    s_waitcnt lgkmcnt(4)
    v_mfma_f32_32x32x16_bf16 v[64:79], v[30:33], v[14:17], v[64:79]
    s_waitcnt lgkmcnt(2)
    v_mfma_f32_32x32x16_bf16 v[80:95], v[34:37], v[14:17], v[80:95]
    s_waitcnt vmcnt(4) lgkmcnt(0)
    s_barrier
    ds_read_b128 v[112:115], v49 offset:16384
    ds_read_b64_tr_b16 v[18:19], v53 offset:12288
    ds_read_b64_tr_b16 v[20:21], v53 offset:13056
    v_mfma_f32_32x32x16_bf16 v[96:111], v[14:17], v[38:41], v[96:111]
    ds_read_b128 v[116:119], v50 offset:16384
    ds_read_b128 v[120:123], v51 offset:16384
    ds_read_b128 v[124:127], v52 offset:16384
    ds_read_b64_tr_b16 v[22:23], v53 offset:12344
    ds_read_b64_tr_b16 v[24:25], v53 offset:13112
    ds_read_b64_tr_b16 v[26:27], v53 offset:12400
    ds_read_b64_tr_b16 v[28:29], v53 offset:13168
    s_waitcnt lgkmcnt(4)
    v_mfma_f32_32x32x16_bf16 v[64:79], v[18:21], v[112:115], v[64:79]
    ds_read_b64_tr_b16 v[30:31], v54 offset:12288
    ds_read_b64_tr_b16 v[32:33], v54 offset:13056
    s_waitcnt lgkmcnt(4)
    v_mfma_f32_32x32x16_bf16 v[80:95], v[22:25], v[112:115], v[80:95]
    ds_read_b64_tr_b16 v[34:35], v54 offset:12344
    ds_read_b64_tr_b16 v[36:37], v54 offset:13112
    s_add_u32 m0, s51, 16384
    s_nop 0
    buffer_load_dwordx4 v42, s[28:31], s49 offen offset:0 lds
    s_waitcnt lgkmcnt(4)
    v_mfma_f32_32x32x16_bf16 v[96:111], v[112:115], v[26:29], v[96:111]
    ds_read_b64_tr_b16 v[38:39], v54 offset:12400
    ds_read_b64_tr_b16 v[40:41], v54 offset:13168
    s_waitcnt lgkmcnt(4)
    v_mfma_f32_32x32x16_bf16 v[64:79], v[30:33], v[116:119], v[64:79]
    ds_read_b64_tr_b16 v[18:19], v55 offset:12288
    ds_read_b64_tr_b16 v[20:21], v55 offset:13056
    buffer_load_dwordx4 v43, s[28:31], s49 offen offset:1024 lds
    s_waitcnt lgkmcnt(4)
    v_mfma_f32_32x32x16_bf16 v[80:95], v[34:37], v[116:119], v[80:95]
    ds_read_b64_tr_b16 v[22:23], v55 offset:12344
    ds_read_b64_tr_b16 v[24:25], v55 offset:13112
    s_waitcnt lgkmcnt(4)
    v_mfma_f32_32x32x16_bf16 v[96:111], v[116:119], v[38:41], v[96:111]
    ds_read_b64_tr_b16 v[26:27], v55 offset:12400
    ds_read_b64_tr_b16 v[28:29], v55 offset:13168
    buffer_load_dwordx4 v44, s[28:31], s49 offen offset:2048 lds
    s_waitcnt lgkmcnt(4)
    v_mfma_f32_32x32x16_bf16 v[64:79], v[18:21], v[120:123], v[64:79]
    ds_read_b64_tr_b16 v[30:31], v56 offset:12288
    ds_read_b64_tr_b16 v[32:33], v56 offset:13056
    s_waitcnt lgkmcnt(4)
    v_mfma_f32_32x32x16_bf16 v[80:95], v[22:25], v[120:123], v[80:95]
    ds_read_b64_tr_b16 v[34:35], v56 offset:12344
    ds_read_b64_tr_b16 v[36:37], v56 offset:13112
    buffer_load_dwordx4 v45, s[28:31], s49 offen offset:3072 lds
    s_add_u32 s49, s49, 128
    s_waitcnt lgkmcnt(4)
    v_mfma_f32_32x32x16_bf16 v[96:111], v[120:123], v[26:29], v[96:111]
    ds_read_b64_tr_b16 v[38:39], v56 offset:12400
    ds_read_b64_tr_b16 v[40:41], v56 offset:13168
    s_waitcnt lgkmcnt(4)
    v_mfma_f32_32x32x16_bf16 v[64:79], v[30:33], v[124:127], v[64:79]
    s_waitcnt lgkmcnt(2)
    v_mfma_f32_32x32x16_bf16 v[80:95], v[34:37], v[124:127], v[80:95]
    s_waitcnt vmcnt(4) lgkmcnt(0)
    s_barrier
    ds_read_b128 v[2:5], v49 offset:0
    ds_read_b64_tr_b16 v[18:19], v53 offset:24576
    ds_read_b64_tr_b16 v[20:21], v53 offset:25344
    v_mfma_f32_32x32x16_bf16 v[96:111], v[124:127], v[38:41], v[96:111]
    ds_read_b128 v[6:9], v50 offset:0
    ds_read_b128 v[10:13], v51 offset:0
    ds_read_b128 v[14:17], v52 offset:0
    ds_read_b64_tr_b16 v[22:23], v53 offset:24632
    ds_read_b64_tr_b16 v[24:25], v53 offset:25400
    ds_read_b64_tr_b16 v[26:27], v53 offset:24688
    ds_read_b64_tr_b16 v[28:29], v53 offset:25456
    s_waitcnt lgkmcnt(4)
    v_mfma_f32_32x32x16_bf16 v[64:79], v[18:21], v[2:5], v[64:79]
    ds_read_b64_tr_b16 v[30:31], v54 offset:24576
    ds_read_b64_tr_b16 v[32:33], v54 offset:25344
    s_waitcnt lgkmcnt(4)
    v_mfma_f32_32x32x16_bf16 v[80:95], v[22:25], v[2:5], v[80:95]
    ds_read_b64_tr_b16 v[34:35], v54 offset:24632
    ds_read_b64_tr_b16 v[36:37], v54 offset:25400
    s_add_u32 m0, s51, 0
    s_nop 0
    buffer_load_dwordx4 v42, s[28:31], s49 offen offset:0 lds
    s_waitcnt lgkmcnt(4)
    v_mfma_f32_32x32x16_bf16 v[96:111], v[2:5], v[26:29], v[96:111]
    ds_read_b64_tr_b16 v[38:39], v54 offset:24688
    ds_read_b64_tr_b16 v[40:41], v54 offset:25456
    s_waitcnt lgkmcnt(4)
    v_mfma_f32_32x32x16_bf16 v[64:79], v[30:33], v[6:9], v[64:79]
    ds_read_b64_tr_b16 v[18:19], v55 offset:24576
    ds_read_b64_tr_b16 v[20:21], v55 offset:25344
    buffer_load_dwordx4 v43, s[28:31], s49 offen offset:1024 lds
    s_waitcnt lgkmcnt(4)
    v_mfma_f32_32x32x16_bf16 v[80:95], v[34:37], v[6:9], v[80:95]
    ds_read_b64_tr_b16 v[22:23], v55 offset:24632
    ds_read_b64_tr_b16 v[24:25], v55 offset:25400
    s_waitcnt lgkmcnt(4)
    v_mfma_f32_32x32x16_bf16 v[96:111], v[6:9], v[38:41], v[96:111]
    ds_read_b64_tr_b16 v[26:27], v55 offset:24688
    ds_read_b64_tr_b16 v[28:29], v55 offset:25456
    buffer_load_dwordx4 v44, s[28:31], s49 offen offset:2048 lds
    s_waitcnt lgkmcnt(4)
    v_mfma_f32_32x32x16_bf16 v[64:79], v[18:21], v[10:13], v[64:79]
    ds_read_b64_tr_b16 v[30:31], v56 offset:24576
    ds_read_b64_tr_b16 v[32:33], v56 offset:25344
    s_waitcnt lgkmcnt(4)
    v_mfma_f32_32x32x16_bf16 v[80:95], v[22:25], v[10:13], v[80:95]
    ds_read_b64_tr_b16 v[34:35], v56 offset:24632
    ds_read_b64_tr_b16 v[36:37], v56 offset:25400
    buffer_load_dwordx4 v45, s[28:31], s49 offen offset:3072 lds
    s_add_u32 s49, s49, 128
    s_waitcnt lgkmcnt(4)
    v_mfma_f32_32x32x16_bf16 v[96:111], v[10:13], v[26:29], v[96:111]
    ds_read_b64_tr_b16 v[38:39], v56 offset:24688
    ds_read_b64_tr_b16 v[40:41], v56 offset:25456
    s_waitcnt lgkmcnt(4)
    v_mfma_f32_32x32x16_bf16 v[64:79], v[30:33], v[14:17], v[64:79]
    s_waitcnt lgkmcnt(2)
    v_mfma_f32_32x32x16_bf16 v[80:95], v[34:37], v[14:17], v[80:95]
    s_waitcnt vmcnt(4) lgkmcnt(0)
    s_barrier
    ds_read_b128 v[112:115], v49 offset:16384
    ds_read_b64_tr_b16 v[18:19], v53 offset:0
    ds_read_b64_tr_b16 v[20:21], v53 offset:768
    v_mfma_f32_32x32x16_bf16 v[96:111], v[14:17], v[38:41], v[96:111]
    ds_read_b128 v[116:119], v50 offset:16384
    ds_read_b128 v[120:123], v51 offset:16384
    ds_read_b128 v[124:127], v52 offset:16384
    ds_read_b64_tr_b16 v[22:23], v53 offset:56
    ds_read_b64_tr_b16 v[24:25], v53 offset:824
    ds_read_b64_tr_b16 v[26:27], v53 offset:112
    ds_read_b64_tr_b16 v[28:29], v53 offset:880
    s_waitcnt lgkmcnt(4)
    v_mfma_f32_32x32x16_bf16 v[64:79], v[18:21], v[112:115], v[64:79]
    ds_read_b64_tr_b16 v[30:31], v54 offset:0
    ds_read_b64_tr_b16 v[32:33], v54 offset:768
    s_waitcnt lgkmcnt(4)
    v_mfma_f32_32x32x16_bf16 v[80:95], v[22:25], v[112:115], v[80:95]
    ds_read_b64_tr_b16 v[34:35], v54 offset:56
    ds_read_b64_tr_b16 v[36:37], v54 offset:824
    s_add_u32 m0, s51, 16384
    s_nop 0
    buffer_load_dwordx4 v42, s[28:31], s49 offen offset:0 lds
    s_waitcnt lgkmcnt(4)
    v_mfma_f32_32x32x16_bf16 v[96:111], v[112:115], v[26:29], v[96:111]
    ds_read_b64_tr_b16 v[38:39], v54 offset:112
    ds_read_b64_tr_b16 v[40:41], v54 offset:880
    s_waitcnt lgkmcnt(4)
    v_mfma_f32_32x32x16_bf16 v[64:79], v[30:33], v[116:119], v[64:79]
    ds_read_b64_tr_b16 v[18:19], v55 offset:0
    ds_read_b64_tr_b16 v[20:21], v55 offset:768
    buffer_load_dwordx4 v43, s[28:31], s49 offen offset:1024 lds
    s_waitcnt lgkmcnt(4)
    v_mfma_f32_32x32x16_bf16 v[80:95], v[34:37], v[116:119], v[80:95]
    ds_read_b64_tr_b16 v[22:23], v55 offset:56
    ds_read_b64_tr_b16 v[24:25], v55 offset:824
    s_waitcnt lgkmcnt(4)
    v_mfma_f32_32x32x16_bf16 v[96:111], v[116:119], v[38:41], v[96:111]
    ds_read_b64_tr_b16 v[26:27], v55 offset:112
    ds_read_b64_tr_b16 v[28:29], v55 offset:880
    buffer_load_dwordx4 v44, s[28:31], s49 offen offset:2048 lds
    s_waitcnt lgkmcnt(4)
    v_mfma_f32_32x32x16_bf16 v[64:79], v[18:21], v[120:123], v[64:79]
    ds_read_b64_tr_b16 v[30:31], v56 offset:0
    ds_read_b64_tr_b16 v[32:33], v56 offset:768
    s_waitcnt lgkmcnt(4)
    v_mfma_f32_32x32x16_bf16 v[80:95], v[22:25], v[120:123], v[80:95]
    ds_read_b64_tr_b16 v[34:35], v56 offset:56
    ds_read_b64_tr_b16 v[36:37], v56 offset:824
    buffer_load_dwordx4 v45, s[28:31], s49 offen offset:3072 lds
    s_add_u32 s49, s49, 128
    s_waitcnt lgkmcnt(4)
    v_mfma_f32_32x32x16_bf16 v[96:111], v[120:123], v[26:29], v[96:111]
    ds_read_b64_tr_b16 v[38:39], v56 offset:112
    ds_read_b64_tr_b16 v[40:41], v56 offset:880
    s_waitcnt lgkmcnt(4)
    v_mfma_f32_32x32x16_bf16 v[64:79], v[30:33], v[124:127], v[64:79]
    s_waitcnt lgkmcnt(2)
    v_mfma_f32_32x32x16_bf16 v[80:95], v[34:37], v[124:127], v[80:95]
    s_waitcnt vmcnt(4) lgkmcnt(0)
    s_barrier
    ds_read_b128 v[2:5], v49 offset:0
    ds_read_b64_tr_b16 v[18:19], v53 offset:12288
    ds_read_b64_tr_b16 v[20:21], v53 offset:13056
    v_mfma_f32_32x32x16_bf16 v[96:111], v[124:127], v[38:41], v[96:111]
    ds_read_b128 v[6:9], v50 offset:0
    ds_read_b128 v[10:13], v51 offset:0
    ds_read_b128 v[14:17], v52 offset:0
    ds_read_b64_tr_b16 v[22:23], v53 offset:12344
    ds_read_b64_tr_b16 v[24:25], v53 offset:13112
    ds_read_b64_tr_b16 v[26:27], v53 offset:12400
    ds_read_b64_tr_b16 v[28:29], v53 offset:13168
    s_waitcnt lgkmcnt(4)
    v_mfma_f32_32x32x16_bf16 v[64:79], v[18:21], v[2:5], v[64:79]
    ds_read_b64_tr_b16 v[30:31], v54 offset:12288
    ds_read_b64_tr_b16 v[32:33], v54 offset:13056
    s_waitcnt lgkmcnt(4)
    v_mfma_f32_32x32x16_bf16 v[80:95], v[22:25], v[2:5], v[80:95]
    ds_read_b64_tr_b16 v[34:35], v54 offset:12344
    ds_read_b64_tr_b16 v[36:37], v54 offset:13112
    s_add_u32 m0, s51, 0
    s_nop 0
    buffer_load_dwordx4 v42, s[28:31], s49 offen offset:0 lds
    s_waitcnt lgkmcnt(4)
    v_mfma_f32_32x32x16_bf16 v[96:111], v[2:5], v[26:29], v[96:111]
    ds_read_b64_tr_b16 v[38:39], v54 offset:12400
    ds_read_b64_tr_b16 v[40:41], v54 offset:13168
    s_waitcnt lgkmcnt(4)
    v_mfma_f32_32x32x16_bf16 v[64:79], v[30:33], v[6:9], v[64:79]
    ds_read_b64_tr_b16 v[18:19], v55 offset:12288
    ds_read_b64_tr_b16 v[20:21], v55 offset:13056
    buffer_load_dwordx4 v43, s[28:31], s49 offen offset:1024 lds
    s_waitcnt lgkmcnt(4)
    v_mfma_f32_32x32x16_bf16 v[80:95], v[34:37], v[6:9], v[80:95]
    ds_read_b64_tr_b16 v[22:23], v55 offset:12344
    ds_read_b64_tr_b16 v[24:25], v55 offset:13112
    s_waitcnt lgkmcnt(4)
    v_mfma_f32_32x32x16_bf16 v[96:111], v[6:9], v[38:41], v[96:111]
    ds_read_b64_tr_b16 v[26:27], v55 offset:12400
    ds_read_b64_tr_b16 v[28:29], v55 offset:13168
    buffer_load_dwordx4 v44, s[28:31], s49 offen offset:2048 lds
    s_waitcnt lgkmcnt(4)
    v_mfma_f32_32x32x16_bf16 v[64:79], v[18:21], v[10:13], v[64:79]
    ds_read_b64_tr_b16 v[30:31], v56 offset:12288
    ds_read_b64_tr_b16 v[32:33], v56 offset:13056
    s_waitcnt lgkmcnt(4)
    v_mfma_f32_32x32x16_bf16 v[80:95], v[22:25], v[10:13], v[80:95]
    ds_read_b64_tr_b16 v[34:35], v56 offset:12344
    ds_read_b64_tr_b16 v[36:37], v56 offset:13112
    buffer_load_dwordx4 v45, s[28:31], s49 offen offset:3072 lds
    s_add_u32 s49, s49, 128
    s_waitcnt lgkmcnt(4)
    v_mfma_f32_32x32x16_bf16 v[96:111], v[10:13], v[26:29], v[96:111]
    ds_read_b64_tr_b16 v[38:39], v56 offset:12400
    ds_read_b64_tr_b16 v[40:41], v56 offset:13168
    s_waitcnt lgkmcnt(4)
    v_mfma_f32_32x32x16_bf16 v[64:79], v[30:33], v[14:17], v[64:79]
    s_waitcnt lgkmcnt(2)
    v_mfma_f32_32x32x16_bf16 v[80:95], v[34:37], v[14:17], v[80:95]
    s_waitcnt vmcnt(4) lgkmcnt(0)
    s_barrier
    ds_read_b128 v[112:115], v49 offset:16384
    ds_read_b64_tr_b16 v[18:19], v53 offset:24576
    ds_read_b64_tr_b16 v[20:21], v53 offset:25344
    v_mfma_f32_32x32x16_bf16 v[96:111], v[14:17], v[38:41], v[96:111]
    ds_read_b128 v[116:119], v50 offset:16384
    ds_read_b128 v[120:123], v51 offset:16384
    ds_read_b128 v[124:127], v52 offset:16384
    ds_read_b64_tr_b16 v[22:23], v53 offset:24632
    ds_read_b64_tr_b16 v[24:25], v53 offset:25400
    ds_read_b64_tr_b16 v[26:27], v53 offset:24688
    ds_read_b64_tr_b16 v[28:29], v53 offset:25456
    s_waitcnt lgkmcnt(4)
    v_mfma_f32_32x32x16_bf16 v[64:79], v[18:21], v[112:115], v[64:79]
    ds_read_b64_tr_b16 v[30:31], v54 offset:24576
    ds_read_b64_tr_b16 v[32:33], v54 offset:25344
    s_waitcnt lgkmcnt(4)
    v_mfma_f32_32x32x16_bf16 v[80:95], v[22:25], v[112:115], v[80:95]
    ds_read_b64_tr_b16 v[34:35], v54 offset:24632
    ds_read_b64_tr_b16 v[36:37], v54 offset:25400
    s_waitcnt lgkmcnt(4)
    v_mfma_f32_32x32x16_bf16 v[96:111], v[112:115], v[26:29], v[96:111]
    ds_read_b64_tr_b16 v[38:39], v54 offset:24688
    ds_read_b64_tr_b16 v[40:41], v54 offset:25456
    s_waitcnt lgkmcnt(4)
    v_mfma_f32_32x32x16_bf16 v[64:79], v[30:33], v[116:119], v[64:79]
    ds_read_b64_tr_b16 v[18:19], v55 offset:24576
    ds_read_b64_tr_b16 v[20:21], v55 offset:25344
    s_waitcnt lgkmcnt(4)
    v_mfma_f32_32x32x16_bf16 v[80:95], v[34:37], v[116:119], v[80:95]
    ds_read_b64_tr_b16 v[22:23], v55 offset:24632
    ds_read_b64_tr_b16 v[24:25], v55 offset:25400
    s_waitcnt lgkmcnt(4)
    v_mfma_f32_32x32x16_bf16 v[96:111], v[116:119], v[38:41], v[96:111]
    ds_read_b64_tr_b16 v[26:27], v55 offset:24688
    ds_read_b64_tr_b16 v[28:29], v55 offset:25456
    s_waitcnt lgkmcnt(4)
    v_mfma_f32_32x32x16_bf16 v[64:79], v[18:21], v[120:123], v[64:79]
    ds_read_b64_tr_b16 v[30:31], v56 offset:24576
    ds_read_b64_tr_b16 v[32:33], v56 offset:25344
    s_waitcnt lgkmcnt(4)
    v_mfma_f32_32x32x16_bf16 v[80:95], v[22:25], v[120:123], v[80:95]
    ds_read_b64_tr_b16 v[34:35], v56 offset:24632
    ds_read_b64_tr_b16 v[36:37], v56 offset:25400
    s_waitcnt lgkmcnt(4)
    v_mfma_f32_32x32x16_bf16 v[96:111], v[120:123], v[26:29], v[96:111]
    ds_read_b64_tr_b16 v[38:39], v56 offset:24688
    ds_read_b64_tr_b16 v[40:41], v56 offset:25456
    s_waitcnt lgkmcnt(4)
    v_mfma_f32_32x32x16_bf16 v[64:79], v[30:33], v[124:127], v[64:79]
    s_waitcnt lgkmcnt(2)
    v_mfma_f32_32x32x16_bf16 v[80:95], v[34:37], v[124:127], v[80:95]
    s_waitcnt vmcnt(0) lgkmcnt(0)
    s_barrier
    ds_read_b128 v[2:5], v49 offset:0
    ds_read_b64_tr_b16 v[18:19], v53 offset:0
    ds_read_b64_tr_b16 v[20:21], v53 offset:768
    v_mfma_f32_32x32x16_bf16 v[96:111], v[124:127], v[38:41], v[96:111]
    ds_read_b128 v[6:9], v50 offset:0
    ds_read_b128 v[10:13], v51 offset:0
    ds_read_b128 v[14:17], v52 offset:0
    ds_read_b64_tr_b16 v[22:23], v53 offset:56
    ds_read_b64_tr_b16 v[24:25], v53 offset:824
    ds_read_b64_tr_b16 v[26:27], v53 offset:112
    ds_read_b64_tr_b16 v[28:29], v53 offset:880
    s_waitcnt lgkmcnt(4)
    v_mfma_f32_32x32x16_bf16 v[64:79], v[18:21], v[2:5], v[64:79]
    ds_read_b64_tr_b16 v[30:31], v54 offset:0
    ds_read_b64_tr_b16 v[32:33], v54 offset:768
    v_and_b32 v46, 31, v1
    s_lshl_b32 s54, s26, 8
    s_add_u32 s54, s54, 76288
    s_waitcnt lgkmcnt(4)
    v_mfma_f32_32x32x16_bf16 v[80:95], v[22:25], v[2:5], v[80:95]
    ds_read_b64_tr_b16 v[34:35], v54 offset:56
    ds_read_b64_tr_b16 v[36:37], v54 offset:824
    v_lshrrev_b32 v47, 5, v1
    v_lshl_add_u32 v48, v47, 4, s54
    v_lshlrev_b32 v47, 4, v47
    s_waitcnt lgkmcnt(4)
    v_mfma_f32_32x32x16_bf16 v[96:111], v[2:5], v[26:29], v[96:111]
    ds_read_b64_tr_b16 v[38:39], v54 offset:112
    ds_read_b64_tr_b16 v[40:41], v54 offset:880
    v_add_u32 v47, 75776, v47
    v_bfe_u32 v57, v1, 4, 1
    v_mul_u32_u24 v57, 64, v57
    s_waitcnt lgkmcnt(4)
    v_mfma_f32_32x32x16_bf16 v[64:79], v[30:33], v[6:9], v[64:79]
    ds_read_b64_tr_b16 v[18:19], v55 offset:0
    ds_read_b64_tr_b16 v[20:21], v55 offset:768
    v_lshl_add_u32 v57, v46, 2, v57
    v_add_u32 v57, s54, v57
    v_lshlrev_b32 v46, 2, v46
    s_waitcnt lgkmcnt(4)
    v_mfma_f32_32x32x16_bf16 v[80:95], v[34:37], v[6:9], v[80:95]
    ds_read_b64_tr_b16 v[22:23], v55 offset:56
    ds_read_b64_tr_b16 v[24:25], v55 offset:824
    v_add_u32 v46, 75776, v46
    v_lshlrev_b32 v63, 4, v1
    v_mov_b32 v60, 1.0
    s_waitcnt lgkmcnt(4)
    v_mfma_f32_32x32x16_bf16 v[96:111], v[6:9], v[38:41], v[96:111]
    ds_read_b64_tr_b16 v[26:27], v55 offset:112
    ds_read_b64_tr_b16 v[28:29], v55 offset:880
    s_mov_b32 exec_lo, 0
    v_mov_b32 v60, 0
    s_mov_b32 exec_lo, -1
    s_waitcnt lgkmcnt(4)
    v_mfma_f32_32x32x16_bf16 v[64:79], v[18:21], v[10:13], v[64:79]
    ds_read_b64_tr_b16 v[30:31], v56 offset:0
    ds_read_b64_tr_b16 v[32:33], v56 offset:768
    s_waitcnt lgkmcnt(4)
    v_mfma_f32_32x32x16_bf16 v[80:95], v[22:25], v[10:13], v[80:95]
    ds_read_b64_tr_b16 v[34:35], v56 offset:56
    ds_read_b64_tr_b16 v[36:37], v56 offset:824
    s_waitcnt lgkmcnt(4)
    v_mfma_f32_32x32x16_bf16 v[96:111], v[10:13], v[26:29], v[96:111]
    ds_read_b64_tr_b16 v[38:39], v56 offset:112
    ds_read_b64_tr_b16 v[40:41], v56 offset:880
    s_waitcnt lgkmcnt(0)
    s_barrier
    ds_read2_b32 v[42:43], v57 offset0:0 offset1:16
    ds_read_b128 v[112:115], v47 offset:0
    ds_read_b128 v[116:119], v47 offset:32
    ds_read_b128 v[120:123], v47 offset:64
    ds_read_b128 v[124:127], v47 offset:96
    ds_read_b32 v61, v46 offset:224
    v_mfma_f32_32x32x16_bf16 v[64:79], v[30:33], v[14:17], v[64:79]
    v_mfma_f32_32x32x16_bf16 v[80:95], v[34:37], v[14:17], v[80:95]
    v_mfma_f32_32x32x16_bf16 v[96:111], v[14:17], v[38:41], v[96:111]
    ds_read_b128 v[2:5], v47 offset:112
    ds_read_b128 v[6:9], v47 offset:144
    ds_read_b128 v[10:13], v47 offset:176
    ds_read_b128 v[14:17], v47 offset:208
    ds_read_b128 v[18:21], v48 offset:0
    ds_read_b128 v[22:25], v48 offset:32
    ds_read_b128 v[26:29], v48 offset:128
    ds_read_b128 v[30:33], v48 offset:160
    s_waitcnt lgkmcnt(8)
    v_mul_f32 v50, s61, v43
    v_mul_f32 v51, s61, v43
    v_mul_f32 v56, s61, v42
    v_mul_f32 v57, s61, v42
    v_mul_f32 v44, v56, v60
    v_mul_f32 v45, v56, v60
    v_mul_f32 v52, v50, v60
    v_mul_f32 v53, v50, v60
    s_waitcnt lgkmcnt(8)
    v_pk_mul_f32 v[64:65], v[64:65], v[56:57]
    v_pk_mul_f32 v[66:67], v[66:67], v[56:57]
    v_pk_mul_f32 v[68:69], v[68:69], v[56:57]
    v_pk_mul_f32 v[70:71], v[70:71], v[56:57]
    v_pk_mul_f32 v[72:73], v[72:73], v[56:57]
    v_pk_mul_f32 v[74:75], v[74:75], v[56:57]
    v_pk_mul_f32 v[76:77], v[76:77], v[44:45]
    v_pk_mul_f32 v[78:79], v[78:79], v[44:45]
    v_pk_fma_f32 v[64:65], v[112:113], v[50:51], v[64:65]
    v_pk_fma_f32 v[66:67], v[114:115], v[50:51], v[66:67]
    v_pk_fma_f32 v[68:69], v[116:117], v[50:51], v[68:69]
    v_pk_fma_f32 v[70:71], v[118:119], v[50:51], v[70:71]
    v_pk_fma_f32 v[72:73], v[120:121], v[50:51], v[72:73]
    v_pk_fma_f32 v[74:75], v[122:123], v[50:51], v[74:75]
    v_pk_fma_f32 v[76:77], v[124:125], v[52:53], v[76:77]
    v_pk_fma_f32 v[78:79], v[126:127], v[52:53], v[78:79]
    ds_read_b128 v[112:115], v48 offset:64
    ds_read_b128 v[116:119], v48 offset:96
    ds_read_b128 v[120:123], v48 offset:192
    ds_read_b128 v[124:127], v48 offset:224
    v_cvt_pk_bf16_f32 v64, v64, v65
    v_cvt_pk_bf16_f32 v65, v66, v67
    v_cvt_pk_bf16_f32 v66, v68, v69
    v_cvt_pk_bf16_f32 v67, v70, v71
    v_cvt_pk_bf16_f32 v68, v72, v73
    v_cvt_pk_bf16_f32 v69, v74, v75
    v_cvt_pk_bf16_f32 v70, v76, v77
    v_cvt_pk_bf16_f32 v71, v78, v79
    buffer_store_dwordx4 v[64:67], v63, s[36:39], s58 offen sc1
    buffer_store_dwordx4 v[68:71], v63, s[36:39], s58 offen offset:1024 sc1
    v_mul_f32 v50, s62, v43
    v_mul_f32 v51, s62, v43
    v_mul_f32 v56, s62, v42
    v_mul_f32 v57, s62, v42
    v_mul_f32 v44, v56, v60
    v_mul_f32 v45, v56, v60
    v_mul_f32 v52, v50, v60
    v_mul_f32 v53, v50, v60
    s_waitcnt lgkmcnt(8)
    v_pk_mul_f32 v[80:81], v[80:81], v[56:57]
    v_pk_mul_f32 v[82:83], v[82:83], v[56:57]
    v_pk_mul_f32 v[84:85], v[84:85], v[56:57]
    v_pk_mul_f32 v[86:87], v[86:87], v[56:57]
    v_pk_mul_f32 v[88:89], v[88:89], v[56:57]
    v_pk_mul_f32 v[90:91], v[90:91], v[56:57]
    v_pk_mul_f32 v[92:93], v[92:93], v[44:45]
    v_pk_mul_f32 v[94:95], v[94:95], v[44:45]
    v_pk_fma_f32 v[80:81], v[2:3], v[50:51], v[80:81]
    v_pk_fma_f32 v[82:83], v[4:5], v[50:51], v[82:83]
    v_pk_fma_f32 v[84:85], v[6:7], v[50:51], v[84:85]
    v_pk_fma_f32 v[86:87], v[8:9], v[50:51], v[86:87]
    v_pk_fma_f32 v[88:89], v[10:11], v[50:51], v[88:89]
    v_pk_fma_f32 v[90:91], v[12:13], v[50:51], v[90:91]
    v_pk_fma_f32 v[92:93], v[14:15], v[52:53], v[92:93]
    v_pk_fma_f32 v[94:95], v[16:17], v[52:53], v[94:95]
    v_cvt_pk_bf16_f32 v80, v80, v81
    v_cvt_pk_bf16_f32 v81, v82, v83
    v_cvt_pk_bf16_f32 v82, v84, v85
    v_cvt_pk_bf16_f32 v83, v86, v87
    v_cvt_pk_bf16_f32 v84, v88, v89
    v_cvt_pk_bf16_f32 v85, v90, v91
    v_cvt_pk_bf16_f32 v86, v92, v93
    v_cvt_pk_bf16_f32 v87, v94, v95
    buffer_store_dwordx4 v[80:83], v63, s[36:39], s59 offen sc1
    buffer_store_dwordx4 v[84:87], v63, s[36:39], s59 offen offset:1024 sc1
    s_waitcnt lgkmcnt(0)
    v_mov_b32 v56, v61
    v_mov_b32 v57, v56
    v_pk_mul_f32 v[96:97], v[96:97], v[18:19]
    v_pk_mul_f32 v[98:99], v[98:99], v[20:21]
    v_pk_mul_f32 v[100:101], v[100:101], v[22:23]
    v_pk_mul_f32 v[102:103], v[102:103], v[24:25]
    v_pk_mul_f32 v[104:105], v[104:105], v[26:27]
    v_pk_mul_f32 v[106:107], v[106:107], v[28:29]
    v_pk_mul_f32 v[108:109], v[108:109], v[30:31]
    v_pk_mul_f32 v[110:111], v[110:111], v[32:33]
    v_pk_fma_f32 v[96:97], v[112:113], v[56:57], v[96:97]
    v_pk_fma_f32 v[98:99], v[114:115], v[56:57], v[98:99]
    v_pk_fma_f32 v[100:101], v[116:117], v[56:57], v[100:101]
    v_pk_fma_f32 v[102:103], v[118:119], v[56:57], v[102:103]
    v_pk_fma_f32 v[104:105], v[120:121], v[56:57], v[104:105]
    v_pk_fma_f32 v[106:107], v[122:123], v[56:57], v[106:107]
    v_pk_fma_f32 v[108:109], v[124:125], v[56:57], v[108:109]
    v_pk_fma_f32 v[110:111], v[126:127], v[56:57], v[110:111]
    v_cvt_pk_bf16_f32 v96, v96, v97
    v_cvt_pk_bf16_f32 v97, v98, v99
    v_cvt_pk_bf16_f32 v98, v100, v101
    v_cvt_pk_bf16_f32 v99, v102, v103
    v_cvt_pk_bf16_f32 v100, v104, v105
    v_cvt_pk_bf16_f32 v101, v106, v107
    v_cvt_pk_bf16_f32 v102, v108, v109
    v_cvt_pk_bf16_f32 v103, v110, v111
    s_mov_b32 exec_lo, 0x10000000
    s_mov_b32 exec_hi, 0x10000000
    v_mov_b32 v96, v62
    v_mov_b32 v97, v62
    v_mov_b32 v98, v62
    v_mov_b32 v99, v62
    v_mov_b32 v100, v62
    v_mov_b32 v101, v62
    v_mov_b32 v102, v62
    v_mov_b32 v103, v62
    s_mov_b64 exec, -1
    buffer_store_dwordx4 v[96:99], v63, s[36:39], s60 offen sc1
    buffer_store_dwordx4 v[100:103], v63, s[36:39], s60 offen offset:1024 sc1
    s_branch a_pub
qkv_vvv:
    s_waitcnt vmcnt(4) lgkmcnt(0)
    s_barrier
    ds_read_b128 v[2:5], v49 offset:0
    ds_read_b128 v[6:9], v50 offset:0
    ds_read_b128 v[10:13], v51 offset:0
    ds_read_b128 v[14:17], v52 offset:0
    ds_read_b64_tr_b16 v[18:19], v53 offset:0
    ds_read_b64_tr_b16 v[20:21], v53 offset:768
    ds_read_b64_tr_b16 v[22:23], v53 offset:56
    ds_read_b64_tr_b16 v[24:25], v53 offset:824
    ds_read_b64_tr_b16 v[26:27], v53 offset:112
    ds_read_b64_tr_b16 v[28:29], v53 offset:880
    s_waitcnt lgkmcnt(4)
    v_mfma_f32_32x32x16_bf16 v[64:79], v[2:5], v[18:21], 0
    ds_read_b64_tr_b16 v[30:31], v54 offset:0
    ds_read_b64_tr_b16 v[32:33], v54 offset:768
    s_waitcnt lgkmcnt(4)
    v_mfma_f32_32x32x16_bf16 v[80:95], v[2:5], v[22:25], 0
    ds_read_b64_tr_b16 v[34:35], v54 offset:56
    ds_read_b64_tr_b16 v[36:37], v54 offset:824
    s_add_u32 m0, s51, 0
    s_nop 0
    buffer_load_dwordx4 v42, s[28:31], s49 offen offset:0 lds
    s_waitcnt lgkmcnt(4)
    v_mfma_f32_32x32x16_bf16 v[96:111], v[2:5], v[26:29], 0
    ds_read_b64_tr_b16 v[38:39], v54 offset:112
    ds_read_b64_tr_b16 v[40:41], v54 offset:880
    s_waitcnt lgkmcnt(4)
    v_mfma_f32_32x32x16_bf16 v[64:79], v[6:9], v[30:33], v[64:79]
    ds_read_b64_tr_b16 v[18:19], v55 offset:0
    ds_read_b64_tr_b16 v[20:21], v55 offset:768
    buffer_load_dwordx4 v43, s[28:31], s49 offen offset:1024 lds
    s_waitcnt lgkmcnt(4)
    v_mfma_f32_32x32x16_bf16 v[80:95], v[6:9], v[34:37], v[80:95]
    ds_read_b64_tr_b16 v[22:23], v55 offset:56
    ds_read_b64_tr_b16 v[24:25], v55 offset:824
    s_waitcnt lgkmcnt(4)
    v_mfma_f32_32x32x16_bf16 v[96:111], v[6:9], v[38:41], v[96:111]
    ds_read_b64_tr_b16 v[26:27], v55 offset:112
    ds_read_b64_tr_b16 v[28:29], v55 offset:880
    buffer_load_dwordx4 v44, s[28:31], s49 offen offset:2048 lds
    s_waitcnt lgkmcnt(4)
    v_mfma_f32_32x32x16_bf16 v[64:79], v[10:13], v[18:21], v[64:79]
    ds_read_b64_tr_b16 v[30:31], v56 offset:0
    ds_read_b64_tr_b16 v[32:33], v56 offset:768
    s_waitcnt lgkmcnt(4)
    v_mfma_f32_32x32x16_bf16 v[80:95], v[10:13], v[22:25], v[80:95]
    ds_read_b64_tr_b16 v[34:35], v56 offset:56
    ds_read_b64_tr_b16 v[36:37], v56 offset:824
    buffer_load_dwordx4 v45, s[28:31], s49 offen offset:3072 lds
    s_add_u32 s49, s49, 128
    s_waitcnt lgkmcnt(4)
    v_mfma_f32_32x32x16_bf16 v[96:111], v[10:13], v[26:29], v[96:111]
    ds_read_b64_tr_b16 v[38:39], v56 offset:112
    ds_read_b64_tr_b16 v[40:41], v56 offset:880
    s_waitcnt lgkmcnt(4)
    v_mfma_f32_32x32x16_bf16 v[64:79], v[14:17], v[30:33], v[64:79]
    s_waitcnt lgkmcnt(2)
    v_mfma_f32_32x32x16_bf16 v[80:95], v[14:17], v[34:37], v[80:95]
    s_waitcnt vmcnt(4) lgkmcnt(0)
    s_barrier
    ds_read_b128 v[112:115], v49 offset:16384
    ds_read_b64_tr_b16 v[18:19], v53 offset:12288
    ds_read_b64_tr_b16 v[20:21], v53 offset:13056
    v_mfma_f32_32x32x16_bf16 v[96:111], v[14:17], v[38:41], v[96:111]
    ds_read_b128 v[116:119], v50 offset:16384
    ds_read_b128 v[120:123], v51 offset:16384
    ds_read_b128 v[124:127], v52 offset:16384
    ds_read_b64_tr_b16 v[22:23], v53 offset:12344
    ds_read_b64_tr_b16 v[24:25], v53 offset:13112
    ds_read_b64_tr_b16 v[26:27], v53 offset:12400
    ds_read_b64_tr_b16 v[28:29], v53 offset:13168
    s_waitcnt lgkmcnt(4)
    v_mfma_f32_32x32x16_bf16 v[64:79], v[112:115], v[18:21], v[64:79]
    ds_read_b64_tr_b16 v[30:31], v54 offset:12288
    ds_read_b64_tr_b16 v[32:33], v54 offset:13056
    s_waitcnt lgkmcnt(4)
    v_mfma_f32_32x32x16_bf16 v[80:95], v[112:115], v[22:25], v[80:95]
    ds_read_b64_tr_b16 v[34:35], v54 offset:12344
    ds_read_b64_tr_b16 v[36:37], v54 offset:13112
    s_add_u32 m0, s51, 16384
    s_nop 0
    buffer_load_dwordx4 v42, s[28:31], s49 offen offset:0 lds
    s_waitcnt lgkmcnt(4)
    v_mfma_f32_32x32x16_bf16 v[96:111], v[112:115], v[26:29], v[96:111]
    ds_read_b64_tr_b16 v[38:39], v54 offset:12400
    ds_read_b64_tr_b16 v[40:41], v54 offset:13168
    s_waitcnt lgkmcnt(4)
    v_mfma_f32_32x32x16_bf16 v[64:79], v[116:119], v[30:33], v[64:79]
    ds_read_b64_tr_b16 v[18:19], v55 offset:12288
    ds_read_b64_tr_b16 v[20:21], v55 offset:13056
    buffer_load_dwordx4 v43, s[28:31], s49 offen offset:1024 lds
    s_waitcnt lgkmcnt(4)
    v_mfma_f32_32x32x16_bf16 v[80:95], v[116:119], v[34:37], v[80:95]
    ds_read_b64_tr_b16 v[22:23], v55 offset:12344
    ds_read_b64_tr_b16 v[24:25], v55 offset:13112
    s_waitcnt lgkmcnt(4)
    v_mfma_f32_32x32x16_bf16 v[96:111], v[116:119], v[38:41], v[96:111]
    ds_read_b64_tr_b16 v[26:27], v55 offset:12400
    ds_read_b64_tr_b16 v[28:29], v55 offset:13168
    buffer_load_dwordx4 v44, s[28:31], s49 offen offset:2048 lds
    s_waitcnt lgkmcnt(4)
    v_mfma_f32_32x32x16_bf16 v[64:79], v[120:123], v[18:21], v[64:79]
    ds_read_b64_tr_b16 v[30:31], v56 offset:12288
    ds_read_b64_tr_b16 v[32:33], v56 offset:13056
    s_waitcnt lgkmcnt(4)
    v_mfma_f32_32x32x16_bf16 v[80:95], v[120:123], v[22:25], v[80:95]
    ds_read_b64_tr_b16 v[34:35], v56 offset:12344
    ds_read_b64_tr_b16 v[36:37], v56 offset:13112
    buffer_load_dwordx4 v45, s[28:31], s49 offen offset:3072 lds
    s_add_u32 s49, s49, 128
    s_waitcnt lgkmcnt(4)
    v_mfma_f32_32x32x16_bf16 v[96:111], v[120:123], v[26:29], v[96:111]
    ds_read_b64_tr_b16 v[38:39], v56 offset:12400
    ds_read_b64_tr_b16 v[40:41], v56 offset:13168
    s_waitcnt lgkmcnt(4)
    v_mfma_f32_32x32x16_bf16 v[64:79], v[124:127], v[30:33], v[64:79]
    s_waitcnt lgkmcnt(2)
    v_mfma_f32_32x32x16_bf16 v[80:95], v[124:127], v[34:37], v[80:95]
    s_waitcnt vmcnt(4) lgkmcnt(0)
    s_barrier
    ds_read_b128 v[2:5], v49 offset:0
    ds_read_b64_tr_b16 v[18:19], v53 offset:24576
    ds_read_b64_tr_b16 v[20:21], v53 offset:25344
    v_mfma_f32_32x32x16_bf16 v[96:111], v[124:127], v[38:41], v[96:111]
    ds_read_b128 v[6:9], v50 offset:0
    ds_read_b128 v[10:13], v51 offset:0
    ds_read_b128 v[14:17], v52 offset:0
    ds_read_b64_tr_b16 v[22:23], v53 offset:24632
    ds_read_b64_tr_b16 v[24:25], v53 offset:25400
    ds_read_b64_tr_b16 v[26:27], v53 offset:24688
    ds_read_b64_tr_b16 v[28:29], v53 offset:25456
    s_waitcnt lgkmcnt(4)
    v_mfma_f32_32x32x16_bf16 v[64:79], v[2:5], v[18:21], v[64:79]
    ds_read_b64_tr_b16 v[30:31], v54 offset:24576
    ds_read_b64_tr_b16 v[32:33], v54 offset:25344
    s_waitcnt lgkmcnt(4)
    v_mfma_f32_32x32x16_bf16 v[80:95], v[2:5], v[22:25], v[80:95]
    ds_read_b64_tr_b16 v[34:35], v54 offset:24632
    ds_read_b64_tr_b16 v[36:37], v54 offset:25400
    s_add_u32 m0, s51, 0
    s_nop 0
    buffer_load_dwordx4 v42, s[28:31], s49 offen offset:0 lds
    s_waitcnt lgkmcnt(4)
    v_mfma_f32_32x32x16_bf16 v[96:111], v[2:5], v[26:29], v[96:111]
    ds_read_b64_tr_b16 v[38:39], v54 offset:24688
    ds_read_b64_tr_b16 v[40:41], v54 offset:25456
    s_waitcnt lgkmcnt(4)
    v_mfma_f32_32x32x16_bf16 v[64:79], v[6:9], v[30:33], v[64:79]
    ds_read_b64_tr_b16 v[18:19], v55 offset:24576
    ds_read_b64_tr_b16 v[20:21], v55 offset:25344
    buffer_load_dwordx4 v43, s[28:31], s49 offen offset:1024 lds
    s_waitcnt lgkmcnt(4)
    v_mfma_f32_32x32x16_bf16 v[80:95], v[6:9], v[34:37], v[80:95]
    ds_read_b64_tr_b16 v[22:23], v55 offset:24632
    ds_read_b64_tr_b16 v[24:25], v55 offset:25400
    s_waitcnt lgkmcnt(4)
    v_mfma_f32_32x32x16_bf16 v[96:111], v[6:9], v[38:41], v[96:111]
    ds_read_b64_tr_b16 v[26:27], v55 offset:24688
    ds_read_b64_tr_b16 v[28:29], v55 offset:25456
    buffer_load_dwordx4 v44, s[28:31], s49 offen offset:2048 lds
    s_waitcnt lgkmcnt(4)
    v_mfma_f32_32x32x16_bf16 v[64:79], v[10:13], v[18:21], v[64:79]
    ds_read_b64_tr_b16 v[30:31], v56 offset:24576
    ds_read_b64_tr_b16 v[32:33], v56 offset:25344
    s_waitcnt lgkmcnt(4)
    v_mfma_f32_32x32x16_bf16 v[80:95], v[10:13], v[22:25], v[80:95]
    ds_read_b64_tr_b16 v[34:35], v56 offset:24632
    ds_read_b64_tr_b16 v[36:37], v56 offset:25400
    buffer_load_dwordx4 v45, s[28:31], s49 offen offset:3072 lds
    s_add_u32 s49, s49, 128
    s_waitcnt lgkmcnt(4)
    v_mfma_f32_32x32x16_bf16 v[96:111], v[10:13], v[26:29], v[96:111]
    ds_read_b64_tr_b16 v[38:39], v56 offset:24688
    ds_read_b64_tr_b16 v[40:41], v56 offset:25456
    s_waitcnt lgkmcnt(4)
    v_mfma_f32_32x32x16_bf16 v[64:79], v[14:17], v[30:33], v[64:79]
    s_waitcnt lgkmcnt(2)
    v_mfma_f32_32x32x16_bf16 v[80:95], v[14:17], v[34:37], v[80:95]
    s_waitcnt vmcnt(4) lgkmcnt(0)
    s_barrier
    ds_read_b128 v[112:115], v49 offset:16384
    ds_read_b64_tr_b16 v[18:19], v53 offset:0
    ds_read_b64_tr_b16 v[20:21], v53 offset:768
    v_mfma_f32_32x32x16_bf16 v[96:111], v[14:17], v[38:41], v[96:111]
    ds_read_b128 v[116:119], v50 offset:16384
    ds_read_b128 v[120:123], v51 offset:16384
    ds_read_b128 v[124:127], v52 offset:16384
    ds_read_b64_tr_b16 v[22:23], v53 offset:56
    ds_read_b64_tr_b16 v[24:25], v53 offset:824
    ds_read_b64_tr_b16 v[26:27], v53 offset:112
    ds_read_b64_tr_b16 v[28:29], v53 offset:880
    s_waitcnt lgkmcnt(4)
    v_mfma_f32_32x32x16_bf16 v[64:79], v[112:115], v[18:21], v[64:79]
    ds_read_b64_tr_b16 v[30:31], v54 offset:0
    ds_read_b64_tr_b16 v[32:33], v54 offset:768
    s_waitcnt lgkmcnt(4)
    v_mfma_f32_32x32x16_bf16 v[80:95], v[112:115], v[22:25], v[80:95]
    ds_read_b64_tr_b16 v[34:35], v54 offset:56
    ds_read_b64_tr_b16 v[36:37], v54 offset:824
    s_add_u32 m0, s51, 16384
    s_nop 0
    buffer_load_dwordx4 v42, s[28:31], s49 offen offset:0 lds
    s_waitcnt lgkmcnt(4)
    v_mfma_f32_32x32x16_bf16 v[96:111], v[112:115], v[26:29], v[96:111]
    ds_read_b64_tr_b16 v[38:39], v54 offset:112
    ds_read_b64_tr_b16 v[40:41], v54 offset:880
    s_waitcnt lgkmcnt(4)
    v_mfma_f32_32x32x16_bf16 v[64:79], v[116:119], v[30:33], v[64:79]
    ds_read_b64_tr_b16 v[18:19], v55 offset:0
    ds_read_b64_tr_b16 v[20:21], v55 offset:768
    buffer_load_dwordx4 v43, s[28:31], s49 offen offset:1024 lds
    s_waitcnt lgkmcnt(4)
    v_mfma_f32_32x32x16_bf16 v[80:95], v[116:119], v[34:37], v[80:95]
    ds_read_b64_tr_b16 v[22:23], v55 offset:56
    ds_read_b64_tr_b16 v[24:25], v55 offset:824
    s_waitcnt lgkmcnt(4)
    v_mfma_f32_32x32x16_bf16 v[96:111], v[116:119], v[38:41], v[96:111]
    ds_read_b64_tr_b16 v[26:27], v55 offset:112
    ds_read_b64_tr_b16 v[28:29], v55 offset:880
    buffer_load_dwordx4 v44, s[28:31], s49 offen offset:2048 lds
    s_waitcnt lgkmcnt(4)
    v_mfma_f32_32x32x16_bf16 v[64:79], v[120:123], v[18:21], v[64:79]
    ds_read_b64_tr_b16 v[30:31], v56 offset:0
    ds_read_b64_tr_b16 v[32:33], v56 offset:768
    s_waitcnt lgkmcnt(4)
    v_mfma_f32_32x32x16_bf16 v[80:95], v[120:123], v[22:25], v[80:95]
    ds_read_b64_tr_b16 v[34:35], v56 offset:56
    ds_read_b64_tr_b16 v[36:37], v56 offset:824
    buffer_load_dwordx4 v45, s[28:31], s49 offen offset:3072 lds
    s_add_u32 s49, s49, 128
    s_waitcnt lgkmcnt(4)
    v_mfma_f32_32x32x16_bf16 v[96:111], v[120:123], v[26:29], v[96:111]
    ds_read_b64_tr_b16 v[38:39], v56 offset:112
    ds_read_b64_tr_b16 v[40:41], v56 offset:880
    s_waitcnt lgkmcnt(4)
    v_mfma_f32_32x32x16_bf16 v[64:79], v[124:127], v[30:33], v[64:79]
    s_waitcnt lgkmcnt(2)
    v_mfma_f32_32x32x16_bf16 v[80:95], v[124:127], v[34:37], v[80:95]
    s_waitcnt vmcnt(4) lgkmcnt(0)
    s_barrier
    ds_read_b128 v[2:5], v49 offset:0
    ds_read_b64_tr_b16 v[18:19], v53 offset:12288
    ds_read_b64_tr_b16 v[20:21], v53 offset:13056
    v_mfma_f32_32x32x16_bf16 v[96:111], v[124:127], v[38:41], v[96:111]
    ds_read_b128 v[6:9], v50 offset:0
    ds_read_b128 v[10:13], v51 offset:0
    ds_read_b128 v[14:17], v52 offset:0
    ds_read_b64_tr_b16 v[22:23], v53 offset:12344
    ds_read_b64_tr_b16 v[24:25], v53 offset:13112
    ds_read_b64_tr_b16 v[26:27], v53 offset:12400
    ds_read_b64_tr_b16 v[28:29], v53 offset:13168
    s_waitcnt lgkmcnt(4)
    v_mfma_f32_32x32x16_bf16 v[64:79], v[2:5], v[18:21], v[64:79]
    ds_read_b64_tr_b16 v[30:31], v54 offset:12288
    ds_read_b64_tr_b16 v[32:33], v54 offset:13056
    s_waitcnt lgkmcnt(4)
    v_mfma_f32_32x32x16_bf16 v[80:95], v[2:5], v[22:25], v[80:95]
    ds_read_b64_tr_b16 v[34:35], v54 offset:12344
    ds_read_b64_tr_b16 v[36:37], v54 offset:13112
    s_add_u32 m0, s51, 0
    s_nop 0
    buffer_load_dwordx4 v42, s[28:31], s49 offen offset:0 lds
    s_waitcnt lgkmcnt(4)
    v_mfma_f32_32x32x16_bf16 v[96:111], v[2:5], v[26:29], v[96:111]
    ds_read_b64_tr_b16 v[38:39], v54 offset:12400
    ds_read_b64_tr_b16 v[40:41], v54 offset:13168
    s_waitcnt lgkmcnt(4)
    v_mfma_f32_32x32x16_bf16 v[64:79], v[6:9], v[30:33], v[64:79]
    ds_read_b64_tr_b16 v[18:19], v55 offset:12288
    ds_read_b64_tr_b16 v[20:21], v55 offset:13056
    buffer_load_dwordx4 v43, s[28:31], s49 offen offset:1024 lds
    s_waitcnt lgkmcnt(4)
    v_mfma_f32_32x32x16_bf16 v[80:95], v[6:9], v[34:37], v[80:95]
    ds_read_b64_tr_b16 v[22:23], v55 offset:12344
    ds_read_b64_tr_b16 v[24:25], v55 offset:13112
    s_waitcnt lgkmcnt(4)
    v_mfma_f32_32x32x16_bf16 v[96:111], v[6:9], v[38:41], v[96:111]
    ds_read_b64_tr_b16 v[26:27], v55 offset:12400
    ds_read_b64_tr_b16 v[28:29], v55 offset:13168
    buffer_load_dwordx4 v44, s[28:31], s49 offen offset:2048 lds
    s_waitcnt lgkmcnt(4)
    v_mfma_f32_32x32x16_bf16 v[64:79], v[10:13], v[18:21], v[64:79]
    ds_read_b64_tr_b16 v[30:31], v56 offset:12288
    ds_read_b64_tr_b16 v[32:33], v56 offset:13056
    s_waitcnt lgkmcnt(4)
    v_mfma_f32_32x32x16_bf16 v[80:95], v[10:13], v[22:25], v[80:95]
    ds_read_b64_tr_b16 v[34:35], v56 offset:12344
    ds_read_b64_tr_b16 v[36:37], v56 offset:13112
    buffer_load_dwordx4 v45, s[28:31], s49 offen offset:3072 lds
    s_add_u32 s49, s49, 128
    s_waitcnt lgkmcnt(4)
    v_mfma_f32_32x32x16_bf16 v[96:111], v[10:13], v[26:29], v[96:111]
    ds_read_b64_tr_b16 v[38:39], v56 offset:12400
    ds_read_b64_tr_b16 v[40:41], v56 offset:13168
    s_waitcnt lgkmcnt(4)
    v_mfma_f32_32x32x16_bf16 v[64:79], v[14:17], v[30:33], v[64:79]
    s_waitcnt lgkmcnt(2)
    v_mfma_f32_32x32x16_bf16 v[80:95], v[14:17], v[34:37], v[80:95]
    s_waitcnt vmcnt(4) lgkmcnt(0)
    s_barrier
    ds_read_b128 v[112:115], v49 offset:16384
    ds_read_b64_tr_b16 v[18:19], v53 offset:24576
    ds_read_b64_tr_b16 v[20:21], v53 offset:25344
    v_mfma_f32_32x32x16_bf16 v[96:111], v[14:17], v[38:41], v[96:111]
    ds_read_b128 v[116:119], v50 offset:16384
    ds_read_b128 v[120:123], v51 offset:16384
    ds_read_b128 v[124:127], v52 offset:16384
    ds_read_b64_tr_b16 v[22:23], v53 offset:24632
    ds_read_b64_tr_b16 v[24:25], v53 offset:25400
    ds_read_b64_tr_b16 v[26:27], v53 offset:24688
    ds_read_b64_tr_b16 v[28:29], v53 offset:25456
    s_waitcnt lgkmcnt(4)
    v_mfma_f32_32x32x16_bf16 v[64:79], v[112:115], v[18:21], v[64:79]
    ds_read_b64_tr_b16 v[30:31], v54 offset:24576
    ds_read_b64_tr_b16 v[32:33], v54 offset:25344
    s_waitcnt lgkmcnt(4)
    v_mfma_f32_32x32x16_bf16 v[80:95], v[112:115], v[22:25], v[80:95]
    ds_read_b64_tr_b16 v[34:35], v54 offset:24632
    ds_read_b64_tr_b16 v[36:37], v54 offset:25400
    s_waitcnt lgkmcnt(4)
    v_mfma_f32_32x32x16_bf16 v[96:111], v[112:115], v[26:29], v[96:111]
    ds_read_b64_tr_b16 v[38:39], v54 offset:24688
    ds_read_b64_tr_b16 v[40:41], v54 offset:25456
    s_waitcnt lgkmcnt(4)
    v_mfma_f32_32x32x16_bf16 v[64:79], v[116:119], v[30:33], v[64:79]
    ds_read_b64_tr_b16 v[18:19], v55 offset:24576
    ds_read_b64_tr_b16 v[20:21], v55 offset:25344
    s_waitcnt lgkmcnt(4)
    v_mfma_f32_32x32x16_bf16 v[80:95], v[116:119], v[34:37], v[80:95]
    ds_read_b64_tr_b16 v[22:23], v55 offset:24632
    ds_read_b64_tr_b16 v[24:25], v55 offset:25400
    s_waitcnt lgkmcnt(4)
    v_mfma_f32_32x32x16_bf16 v[96:111], v[116:119], v[38:41], v[96:111]
    ds_read_b64_tr_b16 v[26:27], v55 offset:24688
    ds_read_b64_tr_b16 v[28:29], v55 offset:25456
    s_waitcnt lgkmcnt(4)
    v_mfma_f32_32x32x16_bf16 v[64:79], v[120:123], v[18:21], v[64:79]
    ds_read_b64_tr_b16 v[30:31], v56 offset:24576
    ds_read_b64_tr_b16 v[32:33], v56 offset:25344
    s_waitcnt lgkmcnt(4)
    v_mfma_f32_32x32x16_bf16 v[80:95], v[120:123], v[22:25], v[80:95]
    ds_read_b64_tr_b16 v[34:35], v56 offset:24632
    ds_read_b64_tr_b16 v[36:37], v56 offset:25400
    s_waitcnt lgkmcnt(4)
    v_mfma_f32_32x32x16_bf16 v[96:111], v[120:123], v[26:29], v[96:111]
    ds_read_b64_tr_b16 v[38:39], v56 offset:24688
    ds_read_b64_tr_b16 v[40:41], v56 offset:25456
    s_waitcnt lgkmcnt(4)
    v_mfma_f32_32x32x16_bf16 v[64:79], v[124:127], v[30:33], v[64:79]
    s_waitcnt lgkmcnt(2)
    v_mfma_f32_32x32x16_bf16 v[80:95], v[124:127], v[34:37], v[80:95]
    s_waitcnt vmcnt(0) lgkmcnt(0)
    s_barrier
    ds_read_b128 v[2:5], v49 offset:0
    ds_read_b64_tr_b16 v[18:19], v53 offset:0
    ds_read_b64_tr_b16 v[20:21], v53 offset:768
    v_mfma_f32_32x32x16_bf16 v[96:111], v[124:127], v[38:41], v[96:111]
    ds_read_b128 v[6:9], v50 offset:0
    ds_read_b128 v[10:13], v51 offset:0
    ds_read_b128 v[14:17], v52 offset:0
    ds_read_b64_tr_b16 v[22:23], v53 offset:56
    ds_read_b64_tr_b16 v[24:25], v53 offset:824
    ds_read_b64_tr_b16 v[26:27], v53 offset:112
    ds_read_b64_tr_b16 v[28:29], v53 offset:880
    s_waitcnt lgkmcnt(4)
    v_mfma_f32_32x32x16_bf16 v[64:79], v[2:5], v[18:21], v[64:79]
    ds_read_b64_tr_b16 v[30:31], v54 offset:0
    ds_read_b64_tr_b16 v[32:33], v54 offset:768
    v_and_b32 v46, 31, v1
    s_lshl_b32 s54, s26, 8
    s_add_u32 s54, s54, 76288
    s_waitcnt lgkmcnt(4)
    v_mfma_f32_32x32x16_bf16 v[80:95], v[2:5], v[22:25], v[80:95]
    ds_read_b64_tr_b16 v[34:35], v54 offset:56
    ds_read_b64_tr_b16 v[36:37], v54 offset:824
    v_lshrrev_b32 v47, 5, v1
    v_lshl_add_u32 v48, v47, 4, s54
    v_lshlrev_b32 v47, 4, v47
    s_waitcnt lgkmcnt(4)
    v_mfma_f32_32x32x16_bf16 v[96:111], v[2:5], v[26:29], v[96:111]
    ds_read_b64_tr_b16 v[38:39], v54 offset:112
    ds_read_b64_tr_b16 v[40:41], v54 offset:880
    v_add_u32 v47, 75776, v47
    v_bfe_u32 v57, v1, 4, 1
    v_mul_u32_u24 v57, 64, v57
    s_waitcnt lgkmcnt(4)
    v_mfma_f32_32x32x16_bf16 v[64:79], v[6:9], v[30:33], v[64:79]
    ds_read_b64_tr_b16 v[18:19], v55 offset:0
    ds_read_b64_tr_b16 v[20:21], v55 offset:768
    v_lshl_add_u32 v57, v46, 2, v57
    v_add_u32 v57, s54, v57
    v_lshlrev_b32 v46, 2, v46
    s_waitcnt lgkmcnt(4)
    v_mfma_f32_32x32x16_bf16 v[80:95], v[6:9], v[34:37], v[80:95]
    ds_read_b64_tr_b16 v[22:23], v55 offset:56
    ds_read_b64_tr_b16 v[24:25], v55 offset:824
    v_add_u32 v46, 75776, v46
    v_lshlrev_b32 v63, 4, v1
    v_mov_b32 v60, 1.0
    s_waitcnt lgkmcnt(4)
    v_mfma_f32_32x32x16_bf16 v[96:111], v[6:9], v[38:41], v[96:111]
    ds_read_b64_tr_b16 v[26:27], v55 offset:112
    ds_read_b64_tr_b16 v[28:29], v55 offset:880
    s_mov_b32 exec_lo, 0
    v_mov_b32 v60, 0
    s_mov_b32 exec_lo, -1
    s_waitcnt lgkmcnt(4)
    v_mfma_f32_32x32x16_bf16 v[64:79], v[10:13], v[18:21], v[64:79]
    ds_read_b64_tr_b16 v[30:31], v56 offset:0
    ds_read_b64_tr_b16 v[32:33], v56 offset:768
    s_waitcnt lgkmcnt(4)
    v_mfma_f32_32x32x16_bf16 v[80:95], v[10:13], v[22:25], v[80:95]
    ds_read_b64_tr_b16 v[34:35], v56 offset:56
    ds_read_b64_tr_b16 v[36:37], v56 offset:824
    s_waitcnt lgkmcnt(4)
    v_mfma_f32_32x32x16_bf16 v[96:111], v[10:13], v[26:29], v[96:111]
    ds_read_b64_tr_b16 v[38:39], v56 offset:112
    ds_read_b64_tr_b16 v[40:41], v56 offset:880
    s_waitcnt lgkmcnt(0)
    s_barrier
    ds_read_b128 v[112:115], v48 offset:0
    ds_read_b128 v[116:119], v48 offset:32
    ds_read_b128 v[120:123], v48 offset:128
    ds_read_b128 v[124:127], v48 offset:160
    ds_read_b32 v58, v46 offset:0
    ds_read_b32 v59, v46 offset:112
    ds_read_b32 v61, v46 offset:224
    v_mfma_f32_32x32x16_bf16 v[64:79], v[14:17], v[30:33], v[64:79]
    v_mfma_f32_32x32x16_bf16 v[80:95], v[14:17], v[34:37], v[80:95]
    v_mfma_f32_32x32x16_bf16 v[96:111], v[14:17], v[38:41], v[96:111]
    ds_read_b128 v[2:5], v48 offset:64
    ds_read_b128 v[6:9], v48 offset:96
    ds_read_b128 v[10:13], v48 offset:192
    ds_read_b128 v[14:17], v48 offset:224
    s_waitcnt lgkmcnt(0)
    v_mov_b32 v56, v58
    v_mov_b32 v57, v56
    s_nop 2
    v_pk_mul_f32 v[64:65], v[64:65], v[112:113]
    v_pk_mul_f32 v[66:67], v[66:67], v[114:115]
    v_pk_mul_f32 v[68:69], v[68:69], v[116:117]
    v_pk_mul_f32 v[70:71], v[70:71], v[118:119]
    v_pk_mul_f32 v[72:73], v[72:73], v[120:121]
    v_pk_mul_f32 v[74:75], v[74:75], v[122:123]
    v_pk_mul_f32 v[76:77], v[76:77], v[124:125]
    v_pk_mul_f32 v[78:79], v[78:79], v[126:127]
    v_pk_fma_f32 v[64:65], v[2:3], v[56:57], v[64:65]
    v_pk_fma_f32 v[66:67], v[4:5], v[56:57], v[66:67]
    v_pk_fma_f32 v[68:69], v[6:7], v[56:57], v[68:69]
    v_pk_fma_f32 v[70:71], v[8:9], v[56:57], v[70:71]
    v_pk_fma_f32 v[72:73], v[10:11], v[56:57], v[72:73]
    v_pk_fma_f32 v[74:75], v[12:13], v[56:57], v[74:75]
    v_pk_fma_f32 v[76:77], v[14:15], v[56:57], v[76:77]
    v_pk_fma_f32 v[78:79], v[16:17], v[56:57], v[78:79]
    v_cvt_pk_bf16_f32 v64, v64, v65
    v_cvt_pk_bf16_f32 v65, v66, v67
    v_cvt_pk_bf16_f32 v66, v68, v69
    v_cvt_pk_bf16_f32 v67, v70, v71
    v_cvt_pk_bf16_f32 v68, v72, v73
    v_cvt_pk_bf16_f32 v69, v74, v75
    v_cvt_pk_bf16_f32 v70, v76, v77
    v_cvt_pk_bf16_f32 v71, v78, v79
    s_mov_b32 exec_lo, 0x10000000
    s_mov_b32 exec_hi, 0x10000000
    v_mov_b32 v64, v62
    v_mov_b32 v65, v62
    v_mov_b32 v66, v62
    v_mov_b32 v67, v62
    v_mov_b32 v68, v62
    v_mov_b32 v69, v62
    v_mov_b32 v70, v62
    v_mov_b32 v71, v62
    s_mov_b64 exec, -1
    buffer_store_dwordx4 v[64:67], v63, s[36:39], s58 offen sc1
    buffer_store_dwordx4 v[68:71], v63, s[36:39], s58 offen offset:1024 sc1
    s_waitcnt lgkmcnt(0)
    v_mov_b32 v56, v59
    v_mov_b32 v57, v56
    v_pk_mul_f32 v[80:81], v[80:81], v[112:113]
    v_pk_mul_f32 v[82:83], v[82:83], v[114:115]
    v_pk_mul_f32 v[84:85], v[84:85], v[116:117]
    v_pk_mul_f32 v[86:87], v[86:87], v[118:119]
    v_pk_mul_f32 v[88:89], v[88:89], v[120:121]
    v_pk_mul_f32 v[90:91], v[90:91], v[122:123]
    v_pk_mul_f32 v[92:93], v[92:93], v[124:125]
    v_pk_mul_f32 v[94:95], v[94:95], v[126:127]
    v_pk_fma_f32 v[80:81], v[2:3], v[56:57], v[80:81]
    v_pk_fma_f32 v[82:83], v[4:5], v[56:57], v[82:83]
    v_pk_fma_f32 v[84:85], v[6:7], v[56:57], v[84:85]
    v_pk_fma_f32 v[86:87], v[8:9], v[56:57], v[86:87]
    v_pk_fma_f32 v[88:89], v[10:11], v[56:57], v[88:89]
    v_pk_fma_f32 v[90:91], v[12:13], v[56:57], v[90:91]
    v_pk_fma_f32 v[92:93], v[14:15], v[56:57], v[92:93]
    v_pk_fma_f32 v[94:95], v[16:17], v[56:57], v[94:95]
    v_cvt_pk_bf16_f32 v80, v80, v81
    v_cvt_pk_bf16_f32 v81, v82, v83
    v_cvt_pk_bf16_f32 v82, v84, v85
    v_cvt_pk_bf16_f32 v83, v86, v87
    v_cvt_pk_bf16_f32 v84, v88, v89
    v_cvt_pk_bf16_f32 v85, v90, v91
    v_cvt_pk_bf16_f32 v86, v92, v93
    v_cvt_pk_bf16_f32 v87, v94, v95
    s_mov_b32 exec_lo, 0x10000000
    s_mov_b32 exec_hi, 0x10000000
    v_mov_b32 v80, v62
    v_mov_b32 v81, v62
    v_mov_b32 v82, v62
    v_mov_b32 v83, v62
    v_mov_b32 v84, v62
    v_mov_b32 v85, v62
    v_mov_b32 v86, v62
    v_mov_b32 v87, v62
    s_mov_b64 exec, -1
    buffer_store_dwordx4 v[80:83], v63, s[36:39], s59 offen sc1
    buffer_store_dwordx4 v[84:87], v63, s[36:39], s59 offen offset:1024 sc1
    s_waitcnt lgkmcnt(0)
    v_mov_b32 v56, v61
    v_mov_b32 v57, v56
    v_pk_mul_f32 v[96:97], v[96:97], v[112:113]
    v_pk_mul_f32 v[98:99], v[98:99], v[114:115]
    v_pk_mul_f32 v[100:101], v[100:101], v[116:117]
    v_pk_mul_f32 v[102:103], v[102:103], v[118:119]
    v_pk_mul_f32 v[104:105], v[104:105], v[120:121]
    v_pk_mul_f32 v[106:107], v[106:107], v[122:123]
    v_pk_mul_f32 v[108:109], v[108:109], v[124:125]
    v_pk_mul_f32 v[110:111], v[110:111], v[126:127]
    v_pk_fma_f32 v[96:97], v[2:3], v[56:57], v[96:97]
    v_pk_fma_f32 v[98:99], v[4:5], v[56:57], v[98:99]
    v_pk_fma_f32 v[100:101], v[6:7], v[56:57], v[100:101]
    v_pk_fma_f32 v[102:103], v[8:9], v[56:57], v[102:103]
    v_pk_fma_f32 v[104:105], v[10:11], v[56:57], v[104:105]
    v_pk_fma_f32 v[106:107], v[12:13], v[56:57], v[106:107]
    v_pk_fma_f32 v[108:109], v[14:15], v[56:57], v[108:109]
    v_pk_fma_f32 v[110:111], v[16:17], v[56:57], v[110:111]
    v_cvt_pk_bf16_f32 v96, v96, v97
    v_cvt_pk_bf16_f32 v97, v98, v99
    v_cvt_pk_bf16_f32 v98, v100, v101
    v_cvt_pk_bf16_f32 v99, v102, v103
    v_cvt_pk_bf16_f32 v100, v104, v105
    v_cvt_pk_bf16_f32 v101, v106, v107
    v_cvt_pk_bf16_f32 v102, v108, v109
    v_cvt_pk_bf16_f32 v103, v110, v111
    s_mov_b32 exec_lo, 0x10000000
    s_mov_b32 exec_hi, 0x10000000
    v_mov_b32 v96, v62
    v_mov_b32 v97, v62
    v_mov_b32 v98, v62
    v_mov_b32 v99, v62
    v_mov_b32 v100, v62
    v_mov_b32 v101, v62
    v_mov_b32 v102, v62
    v_mov_b32 v103, v62
    s_mov_b64 exec, -1
    buffer_store_dwordx4 v[96:99], v63, s[36:39], s60 offen sc1
    buffer_store_dwordx4 v[100:103], v63, s[36:39], s60 offen offset:1024 sc1
    s_branch a_pub
a_help2:
    s_mov_b32 s28, s12
    s_mov_b32 s29, s13
    s_mov_b32 s30, 7340032
    s_mov_b32 s31, 0x20000
    s_lshr_b32 s53, s3, 3
    s_lshl_b32 s53, s53, 2
    s_and_b32 s54, s26, 3
    s_add_u32 s53, s53, s54
    s_lshl_b32 s53, s53, 1
    s_and_b32 s54, s3, 1
    s_add_u32 s53, s53, s54
    s_mul_i32 s53, s53, 28672
    s_bfe_u32 s54, s3, 0x20001
    s_mul_i32 s54, s54, 896
    s_add_u32 s60, s53, s54
    v_mul_u32_u24 v35, 9363, v1
    v_lshrrev_b32 v35, 16, v35
    v_mul_u32_u24 v36, 7, v35
    v_sub_u32 v36, v1, v36
    v_mul_u32_u24 v35, 3584, v35
    v_lshl_add_u32 v35, v36, 7, v35
    s_mov_b32 s40, s22
    s_mov_b32 s41, s23
    s_mov_b32 s42, 256
    s_mov_b32 s43, 0x20000
    v_lshrrev_b32 v3, 5, v1
    v_bfe_u32 v50, v1, 2, 2
    v_lshl_add_u32 v50, v3, 3, v50
    v_mul_u32_u24 v50, 192, v50
    v_bfe_u32 v3, v1, 4, 1
    v_lshl_add_u32 v50, v3, 5, v50
    v_and_b32 v3, 3, v1
    v_lshl_add_u32 v50, v3, 3, v50
    v_add_u32 v50, s52, v50
    v_mov_b32 v41, 0
    s_and_b32 s55, s26, 3
    s_lshl_b32 s56, s27, 3
    s_lshl_b32 s57, s55, 1
    s_add_u32 s56, s56, s57
    s_lshl_b32 s56, s56, 7
    s_add_u32 s57, s56, 12845056
    s_add_u32 s56, s56, 12582912
    v_and_b32 v51, 1, v1
    v_lshlrev_b32 v51, 7, v51
    v_lshlrev_b32 v52, 2, v1
    v_mov_b32 v14, 0x3f803f80
    v_mov_b32 v15, 0x3f803f80
    v_mov_b32 v16, 0x3f803f80
    v_mov_b32 v17, 0x3f803f80
    s_waitcnt vmcnt(3)
    s_barrier
    s_add_u32 m0, s52, 24576
    s_nop 0
    buffer_load_dwordx4 v46, s[32:35], s50 offen offset:0 lds
    buffer_load_dwordx4 v47, s[32:35], s50 offen offset:1024 lds
    buffer_load_dwordx4 v48, s[32:35], s50 offen offset:2048 lds
    s_add_u32 s50, s50, 172032
    s_mov_b32 exec_lo, 16383
    s_mov_b32 exec_hi, 0
    buffer_load_dword v126, v35, s[28:31], s60 offen
    s_mov_b64 exec, -1
    s_add_u32 s60, s60, 7168
    ds_read_b64_tr_b16 v[2:3], v50 offset:0
    ds_read_b64_tr_b16 v[4:5], v50 offset:768
    ds_read_b64_tr_b16 v[6:7], v50 offset:64
    ds_read_b64_tr_b16 v[8:9], v50 offset:832
    ds_read_b64_tr_b16 v[10:11], v50 offset:128
    ds_read_b64_tr_b16 v[12:13], v50 offset:896
    s_waitcnt lgkmcnt(4)
    v_mfma_f32_32x32x16_bf16 v[64:79], v[14:17], v[2:5], 0
    s_waitcnt lgkmcnt(2)
    v_mfma_f32_32x32x16_bf16 v[80:95], v[14:17], v[6:9], 0
    s_waitcnt lgkmcnt(0)
    v_mfma_f32_32x32x16_bf16 v[96:111], v[14:17], v[10:13], 0
    s_waitcnt vmcnt(4)
    s_barrier
    s_add_u32 m0, s52, 0
    s_nop 0
    buffer_load_dwordx4 v46, s[32:35], s50 offen offset:0 lds
    buffer_load_dwordx4 v47, s[32:35], s50 offen offset:1024 lds
    buffer_load_dwordx4 v48, s[32:35], s50 offen offset:2048 lds
    s_add_u32 s50, s50, 172032
    s_mov_b32 exec_lo, 16383
    s_mov_b32 exec_hi, 0
    buffer_load_dword v126, v35, s[28:31], s60 offen
    s_mov_b64 exec, -1
    s_add_u32 s60, s60, 7168
    ds_read_b64_tr_b16 v[2:3], v50 offset:12288
    ds_read_b64_tr_b16 v[4:5], v50 offset:13056
    ds_read_b64_tr_b16 v[6:7], v50 offset:12352
    ds_read_b64_tr_b16 v[8:9], v50 offset:13120
    ds_read_b64_tr_b16 v[10:11], v50 offset:12416
    ds_read_b64_tr_b16 v[12:13], v50 offset:13184
    s_waitcnt lgkmcnt(4)
    v_mfma_f32_32x32x16_bf16 v[64:79], v[14:17], v[2:5], v[64:79]
    s_waitcnt lgkmcnt(2)
    v_mfma_f32_32x32x16_bf16 v[80:95], v[14:17], v[6:9], v[80:95]
    s_waitcnt lgkmcnt(0)
    v_mfma_f32_32x32x16_bf16 v[96:111], v[14:17], v[10:13], v[96:111]
    s_waitcnt vmcnt(5)
    s_barrier
    s_add_u32 m0, s52, 12288
    s_nop 0
    buffer_load_dwordx4 v46, s[32:35], s50 offen offset:0 lds
    buffer_load_dwordx4 v47, s[32:35], s50 offen offset:1024 lds
    buffer_load_dwordx4 v48, s[32:35], s50 offen offset:2048 lds
    s_add_u32 s50, s50, 172032
    buffer_load_dword v40, v41, s[40:43], 0 offen sc1
    s_mov_b32 exec_lo, 16383
    s_mov_b32 exec_hi, 0
    buffer_load_dword v126, v35, s[28:31], s60 offen
    s_mov_b64 exec, -1
    s_add_u32 s60, s60, 7168
    ds_read_b64_tr_b16 v[2:3], v50 offset:24576
    ds_read_b64_tr_b16 v[4:5], v50 offset:25344
    ds_read_b64_tr_b16 v[6:7], v50 offset:24640
    ds_read_b64_tr_b16 v[8:9], v50 offset:25408
    ds_read_b64_tr_b16 v[10:11], v50 offset:24704
    ds_read_b64_tr_b16 v[12:13], v50 offset:25472
    s_waitcnt lgkmcnt(4)
    v_mfma_f32_32x32x16_bf16 v[64:79], v[14:17], v[2:5], v[64:79]
    s_waitcnt lgkmcnt(2)
    v_mfma_f32_32x32x16_bf16 v[80:95], v[14:17], v[6:9], v[80:95]
    s_waitcnt lgkmcnt(0)
    v_mfma_f32_32x32x16_bf16 v[96:111], v[14:17], v[10:13], v[96:111]
    s_waitcnt vmcnt(6)
    s_barrier
    s_add_u32 m0, s52, 24576
    s_nop 0
    buffer_load_dwordx4 v46, s[32:35], s50 offen offset:0 lds
    buffer_load_dwordx4 v47, s[32:35], s50 offen offset:1024 lds
    buffer_load_dwordx4 v48, s[32:35], s50 offen offset:2048 lds
    s_add_u32 s50, s50, 172032
    s_waitcnt vmcnt(4)
    v_cmp_eq_u32 vcc, 0, v40
    s_cbranch_vccz qh_tag_ok
    s_mov_b32 s45, 200000
qh_tag:
    buffer_load_dword v40, v41, s[40:43], 0 offen sc1
    s_waitcnt vmcnt(0)
    v_cmp_eq_u32 vcc, 0, v40
    s_and_b64 exec, exec, vcc
    s_cbranch_execz qh_tag_ok
    s_sleep 2
    s_sub_u32 s45, s45, 1
    s_cbranch_scc0 qh_tag
qh_tag_ok:
    s_mov_b64 exec, -1
    s_mov_b32 exec_lo, 16383
    s_mov_b32 exec_hi, 0
    buffer_load_dword v126, v35, s[28:31], s60 offen
    s_mov_b64 exec, -1
    s_add_u32 s60, s60, 7168
    ds_read_b64_tr_b16 v[2:3], v50 offset:0
    ds_read_b64_tr_b16 v[4:5], v50 offset:768
    ds_read_b64_tr_b16 v[6:7], v50 offset:64
    ds_read_b64_tr_b16 v[8:9], v50 offset:832
    ds_read_b64_tr_b16 v[10:11], v50 offset:128
    ds_read_b64_tr_b16 v[12:13], v50 offset:896
    s_waitcnt lgkmcnt(4)
    v_mfma_f32_32x32x16_bf16 v[64:79], v[14:17], v[2:5], v[64:79]
    s_waitcnt lgkmcnt(2)
    v_mfma_f32_32x32x16_bf16 v[80:95], v[14:17], v[6:9], v[80:95]
    s_waitcnt lgkmcnt(0)
    v_mfma_f32_32x32x16_bf16 v[96:111], v[14:17], v[10:13], v[96:111]
    s_waitcnt vmcnt(5)
    s_barrier
    s_add_u32 m0, s52, 0
    s_nop 0
    buffer_load_dwordx4 v46, s[32:35], s50 offen offset:0 lds
    buffer_load_dwordx4 v47, s[32:35], s50 offen offset:1024 lds
    buffer_load_dwordx4 v48, s[32:35], s50 offen offset:2048 lds
    s_add_u32 s50, s50, 172032
    buffer_load_dword v42, v51, s[36:39], s56 offen sc1
    ds_read_b64_tr_b16 v[2:3], v50 offset:12288
    ds_read_b64_tr_b16 v[4:5], v50 offset:13056
    ds_read_b64_tr_b16 v[6:7], v50 offset:12352
    ds_read_b64_tr_b16 v[8:9], v50 offset:13120
    ds_read_b64_tr_b16 v[10:11], v50 offset:12416
    ds_read_b64_tr_b16 v[12:13], v50 offset:13184
    s_waitcnt lgkmcnt(4)
    v_mfma_f32_32x32x16_bf16 v[64:79], v[14:17], v[2:5], v[64:79]
    s_waitcnt lgkmcnt(2)
    v_mfma_f32_32x32x16_bf16 v[80:95], v[14:17], v[6:9], v[80:95]
    s_waitcnt lgkmcnt(0)
    v_mfma_f32_32x32x16_bf16 v[96:111], v[14:17], v[10:13], v[96:111]
    s_waitcnt vmcnt(5)
    s_barrier
    ds_read_b64_tr_b16 v[2:3], v50 offset:24576
    ds_read_b64_tr_b16 v[4:5], v50 offset:25344
    ds_read_b64_tr_b16 v[6:7], v50 offset:24640
    ds_read_b64_tr_b16 v[8:9], v50 offset:25408
    ds_read_b64_tr_b16 v[10:11], v50 offset:24704
    ds_read_b64_tr_b16 v[12:13], v50 offset:25472
    s_waitcnt lgkmcnt(4)
    v_mfma_f32_32x32x16_bf16 v[64:79], v[14:17], v[2:5], v[64:79]
    s_waitcnt lgkmcnt(2)
    v_mfma_f32_32x32x16_bf16 v[80:95], v[14:17], v[6:9], v[80:95]
    s_waitcnt lgkmcnt(0)
    v_mfma_f32_32x32x16_bf16 v[96:111], v[14:17], v[10:13], v[96:111]
    s_waitcnt vmcnt(0)
    v_cmp_ne_u32 vcc, v42, v40
    s_cbranch_vccz qh_st_ok
    s_mov_b32 s45, 200000
qh_st:
    buffer_load_dword v42, v51, s[36:39], s56 offen sc1
    s_waitcnt vmcnt(0)
    v_cmp_ne_u32 vcc, v42, v40
    s_and_b64 exec, exec, vcc
    s_cbranch_execz qh_st_ok
    s_sleep 3
    s_sub_u32 s45, s45, 1
    s_cbranch_scc0 qh_st
qh_st_ok:
    s_mov_b64 exec, -1
    buffer_load_dword v34, v52, s[36:39], s57 offen sc1
    ds_read_b64_tr_b16 v[2:3], v50 offset:0
    ds_read_b64_tr_b16 v[4:5], v50 offset:768
    ds_read_b64_tr_b16 v[6:7], v50 offset:64
    ds_read_b64_tr_b16 v[8:9], v50 offset:832
    ds_read_b64_tr_b16 v[10:11], v50 offset:128
    ds_read_b64_tr_b16 v[12:13], v50 offset:896
    s_waitcnt lgkmcnt(4)
    v_mfma_f32_32x32x16_bf16 v[64:79], v[14:17], v[2:5], v[64:79]
    s_waitcnt lgkmcnt(2)
    v_mfma_f32_32x32x16_bf16 v[80:95], v[14:17], v[6:9], v[80:95]
    s_waitcnt lgkmcnt(0)
    v_mfma_f32_32x32x16_bf16 v[96:111], v[14:17], v[10:13], v[96:111]
    s_mul_i32 s53, s55, 384
    s_add_u32 s53, s53, 69632
    v_and_b32 v3, 31, v1
    v_lshl_add_u32 v3, v3, 2, s53
    s_mul_i32 s53, s55, 96
    v_min_u32 v50, 23, v1
    v_lshl_add_u32 v50, v50, 2, s53
    v_add_u32 v51, 75776, v50
    v_add_u32 v50, 69632, v50
    s_lshl_b32 s53, s55, 8
    s_add_u32 s53, s53, 76288
    v_add_u32 v52, s53, v52
    ds_write_b32 v3, v64 offset:0
    ds_write_b32 v3, v80 offset:128
    ds_write_b32 v3, v96 offset:256
    s_waitcnt lgkmcnt(0)
    s_waitcnt vmcnt(2)
    s_barrier
    ds_read_b32 v2, v50 offset:0
    ds_read_b32 v3, v50 offset:384
    ds_read_b32 v4, v50 offset:768
    ds_read_b32 v5, v50 offset:1152
    s_waitcnt vmcnt(0)
    ds_write_b32 v52, v34
    s_waitcnt lgkmcnt(1)
    v_add_f32 v2, v2, v3
    v_add_f32 v4, v4, v5
    v_add_f32 v2, v2, v4
    ds_write_b32 v51, v2
    s_waitcnt lgkmcnt(0)
    s_barrier
a_pub:
    s_lshl_b32 s53, s48, 4
    s_add_u32 s53, s53, s27
    s_lshl_b32 s53, s53, 7
    s_add_u32 s44, s53, 12615680
    s_and_b32 s53, s3, 7
    s_lshr_b32 s54, s3, 3
    s_lshl_b32 s53, s53, 1
    s_lshr_b32 s55, s54, 4
    s_add_u32 s27, s53, s55
    s_and_b32 s47, s54, 15
    s_lshl_b32 s54, s47, 2
    s_and_b32 s55, s26, 3
    s_add_u32 s57, s54, s55
    s_lshl_b32 s53, s27, 6
    s_add_u32 s53, s53, s57
    s_lshl_b32 s50, s53, 11
    s_lshl_b32 s48, s27, 18
    s_add_u32 s48, s48, 2097152
    s_mov_b32 s58, s48
    s_lshl_b32 s59, s47, 31
    s_and_b32 s59, s59, 0x3ffff
    s_add_u32 s48, s58, s59
    s_lshl_b32 s49, s26, 11
    s_lshr_b32 s53, s26, 2
    s_lshl_b32 s53, s53, 13
    v_lshlrev_b32 v114, 4, v1
    v_add_u32 v115, s49, v114
    v_add_u32 v120, s53, v114
    s_mov_b32 s28, s16
    s_mov_b32 s29, s17
    s_mov_b32 s30, 7340032
    s_mov_b32 s31, 0x20000
    s_mov_b32 s32, s8
    s_mov_b32 s33, s9
    s_mov_b32 s34, 401408
    s_mov_b32 s35, 0x20000
    s_lshr_b32 s53, s3, 3
    s_lshl_b32 s53, s53, 3
    s_add_u32 s53, s53, s26
    s_mul_i32 s54, s53, 7
    s_bfe_u32 s51, s3, 0x20001
    s_lshl_b32 s51, s51, 10
    s_and_b32 s52, s3, 1
    s_mul_i32 s52, s52, 384
    v_add_u32 v121, s54, v1
    v_and_b32 v122, 3, v121
    v_lshrrev_b32 v123, 2, v121
    v_mul_u32_u24 v123, 896, v123
    v_lshl_add_u32 v122, v122, 7, v123
    v_and_b32 v123, 7, v121
    v_lshrrev_b32 v121, 3, v121
    v_lshlrev_b32 v121, 12, v121
    v_lshl_add_u32 v121, v123, 7, v121
    s_mov_b32 exec_lo, 0xffffff80
    v_mov_b32 v121, 1073741824
    v_mov_b32 v122, 1073741824
    s_mov_b32 exec_lo, -1
    s_waitcnt vmcnt(0)
    s_barrier
    s_cmp_lg_u32 s26, 4
    s_cbranch_scc1 a_go
    v_lshlrev_b32 v41, 2, v1
    s_mov_b32 exec_hi, 0
    buffer_store_dword v40, v41, s[36:39], s44 offen sc1
    s_mov_b32 exec_hi, -1
    s_mul_i32 s53, s27, 0x5556
    s_lshr_b32 s53, s53, 16
    s_lshl_b32 s53, s53, 4
    s_add_u32 s53, s53, s47
    s_lshl_b32 s53, s53, 7
    s_add_u32 s44, s53, 12615680
    v_mov_b32 v2, 0
    v_readfirstlane_b32 s46, v40
    s_mov_b64 exec, 1
    s_mov_b32 s45, 200000
a_wq:
    buffer_load_dword v42, v2, s[36:39], s44 offen sc1
    s_waitcnt vmcnt(0)
    v_cmp_ne_u32 vcc, v42, v40
    s_and_b64 exec, exec, vcc
    s_cbranch_execz a_wq_ok
    s_sleep 3
    s_sub_u32 s45, s45, 1
    s_cbranch_scc0 a_wq
a_wq_ok:
    s_mov_b64 exec, -1
a_go:
    s_barrier
    buffer_load_dwordx4 v[74:77], v114, s[36:39], s50 offen sc1
    buffer_load_dwordx4 v[78:81], v114, s[36:39], s50 offen offset:1024 sc1
    s_cmp_lg_u32 s26, 4
    s_cbranch_scc1 a_go2
    s_lshl_b32 s44, s27, 7
    s_add_u32 s44, s44, 12716032
    v_mov_b32 v2, 0
    s_mov_b64 exec, 1
    s_mov_b32 s45, 200000
a_wkv:
    buffer_load_dword v42, v2, s[36:39], s44 offen sc1
    s_waitcnt vmcnt(0)
    v_cmp_ne_u32 vcc, v42, v40
    s_and_b64 exec, exec, vcc
    s_cbranch_execz a_wkv_ok
    s_sleep 3
    s_sub_u32 s45, s45, 1
    s_cbranch_scc0 a_wkv
a_wkv_ok:
    s_mov_b64 exec, -1
a_go2:
    s_barrier
    s_add_u32 m0, s49, 0
    s_nop 0
    buffer_load_dwordx4 v115, s[36:39], s48 offen offset:0 sc1 lds
    buffer_load_dwordx4 v115, s[36:39], s48 offen offset:1024 sc1 lds
    s_add_u32 s59, s59, 16384
    s_and_b32 s59, s59, 0x3ffff
    s_add_u32 s48, s58, s59
    s_add_u32 m0, s49, 16384
    s_nop 0
    buffer_load_dwordx4 v115, s[36:39], s48 offen offset:0 sc1 lds
    buffer_load_dwordx4 v115, s[36:39], s48 offen offset:1024 sc1 lds
    s_add_u32 s59, s59, 16384
    s_and_b32 s59, s59, 0x3ffff
    s_add_u32 s48, s58, s59
    s_add_u32 m0, s49, 32768
    s_nop 0
    buffer_load_dwordx4 v115, s[36:39], s48 offen offset:0 sc1 lds
    buffer_load_dwordx4 v115, s[36:39], s48 offen offset:1024 sc1 lds
    s_add_u32 s59, s59, 16384
    s_and_b32 s59, s59, 0x3ffff
    s_add_u32 s48, s58, s59
    s_waitcnt vmcnt(4)
    s_barrier
    ds_read_b128 v[34:37], v114
    ds_read_b128 v[38:41], v114 offset:1024
    ds_read_b128 v[98:101], v120 offset:0
    ds_read_b128 v[106:109], v120 offset:1024
    ds_read_b128 v[82:85], v120 offset:4096
    ds_read_b128 v[90:93], v120 offset:5120
    ds_read_b128 v[94:97], v120 offset:2048
    s_waitcnt lgkmcnt(5)
    v_mfma_f32_32x32x16_bf16 v[2:17], v[34:37], v[74:77], 0
    v_mfma_f32_32x32x16_bf16 v[2:17], v[38:41], v[78:81], v[2:17]
    s_nop 11
    v_max3_f32 v116, v2, v3, v4
    v_max3_f32 v117, v5, v6, v7
    v_max3_f32 v116, v116, v8, v9
    v_max3_f32 v117, v117, v10, v11
    v_max3_f32 v116, v116, v12, v13
    v_max3_f32 v117, v117, v14, v15
    v_max3_f32 v116, v116, v16, v17
    v_max_f32 v116, v116, v117
    v_mov_b32 v117, v116
    s_nop 1
    v_permlane32_swap_b32 v116, v117
    v_max_f32 v116, v116, v117
    v_sub_f32 v58, 0, v116
    v_mov_b32 v59, v58
    v_mov_b32 v60, v58
    v_mov_b32 v61, v58
    v_mov_b32 v62, v58
    v_mov_b32 v63, v58
    v_mov_b32 v64, v58
    v_mov_b32 v65, v58
    v_mov_b32 v66, v58
    v_mov_b32 v67, v58
    v_mov_b32 v68, v58
    v_mov_b32 v69, v58
    v_mov_b32 v70, v58
    v_mov_b32 v71, v58
    v_mov_b32 v72, v58
    v_mov_b32 v73, v58
    s_waitcnt lgkmcnt(0)
    s_nop 0
    v_mfma_f32_32x32x16_bf16 v[2:17], v[98:101], v[74:77], v[58:73]
    v_mfma_f32_32x32x16_bf16 v[2:17], v[106:109], v[78:81], v[2:17]
    s_waitcnt vmcnt(2)
    s_barrier
    v_mfma_f32_32x32x16_bf16 v[18:33], v[82:85], v[74:77], v[58:73]
    ds_read_b128 v[98:101], v120 offset:16384
    s_nop 7
    v_exp_f32 v2, v2
    v_exp_f32 v3, v3
    v_exp_f32 v4, v4
    v_cvt_pk_bf16_f32 v34, v2, v3
    v_exp_f32 v5, v5
    v_exp_f32 v6, v6
    v_cvt_pk_bf16_f32 v35, v4, v5
    ds_read_b128 v[106:109], v120 offset:17408
    v_exp_f32 v7, v7
    v_exp_f32 v8, v8
    v_cvt_pk_bf16_f32 v36, v6, v7
    v_exp_f32 v9, v9
    v_exp_f32 v10, v10
    v_cvt_pk_bf16_f32 v37, v8, v9
    v_mfma_f32_32x32x16_bf16 v[18:33], v[90:93], v[78:81], v[18:33]
    ds_read_b128 v[102:105], v120 offset:3072
    ds_read_b128 v[110:113], v120 offset:6144
    v_exp_f32 v11, v11
    v_exp_f32 v12, v12
    v_cvt_pk_bf16_f32 v38, v10, v11
    v_exp_f32 v13, v13
    v_exp_f32 v14, v14
    v_cvt_pk_bf16_f32 v39, v12, v13
    v_mfma_f32_32x32x16_bf16 v[42:57], v[94:97], v[34:37], 0
    s_add_u32 m0, s49, 49152
    s_nop 0
    buffer_load_dwordx4 v115, s[36:39], s48 offen offset:0 sc1 lds
    v_exp_f32 v15, v15
    v_exp_f32 v16, v16
    v_cvt_pk_bf16_f32 v40, v14, v15
    v_exp_f32 v17, v17
    s_waitcnt lgkmcnt(0)
    v_cvt_pk_bf16_f32 v41, v16, v17
    v_mfma_f32_32x32x16_bf16 v[2:17], v[98:101], v[74:77], v[58:73]
    ds_read_b128 v[82:85], v120 offset:20480
    v_exp_f32 v18, v18
    v_exp_f32 v19, v19
    v_exp_f32 v20, v20
    v_cvt_pk_bf16_f32 v34, v18, v19
    v_exp_f32 v21, v21
    v_exp_f32 v22, v22
    v_cvt_pk_bf16_f32 v35, v20, v21
    v_mfma_f32_32x32x16_bf16 v[42:57], v[102:105], v[38:41], v[42:57]
    ds_read_b128 v[90:93], v120 offset:21504
    v_exp_f32 v23, v23
    v_exp_f32 v24, v24
    v_cvt_pk_bf16_f32 v36, v22, v23
    v_exp_f32 v25, v25
    v_exp_f32 v26, v26
    v_cvt_pk_bf16_f32 v37, v24, v25
    v_mfma_f32_32x32x16_bf16 v[2:17], v[106:109], v[78:81], v[2:17]
    ds_read_b128 v[86:89], v120 offset:7168
    ds_read_b128 v[94:97], v120 offset:18432
    v_exp_f32 v27, v27
    v_exp_f32 v28, v28
    v_cvt_pk_bf16_f32 v38, v26, v27
    v_exp_f32 v29, v29
    v_exp_f32 v30, v30
    v_cvt_pk_bf16_f32 v39, v28, v29
    v_mfma_f32_32x32x16_bf16 v[42:57], v[110:113], v[34:37], v[42:57]
    buffer_load_dwordx4 v115, s[36:39], s48 offen offset:1024 sc1 lds
    s_add_u32 s59, s59, 16384
    s_and_b32 s59, s59, 0x3ffff
    s_add_u32 s48, s58, s59
    v_exp_f32 v31, v31
    v_exp_f32 v32, v32
    v_cvt_pk_bf16_f32 v40, v30, v31
    v_exp_f32 v33, v33
    s_waitcnt lgkmcnt(0)
    v_cvt_pk_bf16_f32 v41, v32, v33
    s_waitcnt vmcnt(2)
    s_barrier
    v_mfma_f32_32x32x16_bf16 v[18:33], v[82:85], v[74:77], v[58:73]
    ds_read_b128 v[98:101], v120 offset:32768
    v_exp_f32 v2, v2
    v_exp_f32 v3, v3
    v_exp_f32 v4, v4
    v_cvt_pk_bf16_f32 v34, v2, v3
    v_exp_f32 v5, v5
    v_exp_f32 v6, v6
    v_cvt_pk_bf16_f32 v35, v4, v5
    v_mfma_f32_32x32x16_bf16 v[42:57], v[86:89], v[38:41], v[42:57]
    ds_read_b128 v[106:109], v120 offset:33792
    v_exp_f32 v7, v7
    v_exp_f32 v8, v8
    v_cvt_pk_bf16_f32 v36, v6, v7
    v_exp_f32 v9, v9
    v_exp_f32 v10, v10
    v_cvt_pk_bf16_f32 v37, v8, v9
    v_mfma_f32_32x32x16_bf16 v[18:33], v[90:93], v[78:81], v[18:33]
    ds_read_b128 v[102:105], v120 offset:19456
    ds_read_b128 v[110:113], v120 offset:22528
    v_exp_f32 v11, v11
    v_exp_f32 v12, v12
    v_cvt_pk_bf16_f32 v38, v10, v11
    v_exp_f32 v13, v13
    v_exp_f32 v14, v14
    v_cvt_pk_bf16_f32 v39, v12, v13
    v_mfma_f32_32x32x16_bf16 v[42:57], v[94:97], v[34:37], v[42:57]
    s_add_u32 m0, s49, 0
    s_nop 0
    buffer_load_dwordx4 v115, s[36:39], s48 offen offset:0 sc1 lds
    v_exp_f32 v15, v15
    v_exp_f32 v16, v16
    v_cvt_pk_bf16_f32 v40, v14, v15
    v_exp_f32 v17, v17
    s_waitcnt lgkmcnt(0)
    v_cvt_pk_bf16_f32 v41, v16, v17
    v_mfma_f32_32x32x16_bf16 v[2:17], v[98:101], v[74:77], v[58:73]
    ds_read_b128 v[82:85], v120 offset:36864
    v_exp_f32 v18, v18
    v_exp_f32 v19, v19
    v_exp_f32 v20, v20
    v_cvt_pk_bf16_f32 v34, v18, v19
    v_exp_f32 v21, v21
    v_exp_f32 v22, v22
    v_cvt_pk_bf16_f32 v35, v20, v21
    v_mfma_f32_32x32x16_bf16 v[42:57], v[102:105], v[38:41], v[42:57]
    ds_read_b128 v[90:93], v120 offset:37888
    v_exp_f32 v23, v23
    v_exp_f32 v24, v24
    v_cvt_pk_bf16_f32 v36, v22, v23
    v_exp_f32 v25, v25
    v_exp_f32 v26, v26
    v_cvt_pk_bf16_f32 v37, v24, v25
    v_mfma_f32_32x32x16_bf16 v[2:17], v[106:109], v[78:81], v[2:17]
    ds_read_b128 v[86:89], v120 offset:23552
    ds_read_b128 v[94:97], v120 offset:34816
    v_exp_f32 v27, v27
    v_exp_f32 v28, v28
    v_cvt_pk_bf16_f32 v38, v26, v27
    v_exp_f32 v29, v29
    v_exp_f32 v30, v30
    v_cvt_pk_bf16_f32 v39, v28, v29
    v_mfma_f32_32x32x16_bf16 v[42:57], v[110:113], v[34:37], v[42:57]
    buffer_load_dwordx4 v115, s[36:39], s48 offen offset:1024 sc1 lds
    s_add_u32 s59, s59, 16384
    s_and_b32 s59, s59, 0x3ffff
    s_add_u32 s48, s58, s59
    v_exp_f32 v31, v31
    v_exp_f32 v32, v32
    v_cvt_pk_bf16_f32 v40, v30, v31
    v_exp_f32 v33, v33
    s_waitcnt lgkmcnt(0)
    v_cvt_pk_bf16_f32 v41, v32, v33
    s_waitcnt vmcnt(2)
    s_barrier
    v_mfma_f32_32x32x16_bf16 v[18:33], v[82:85], v[74:77], v[58:73]
    ds_read_b128 v[98:101], v120 offset:49152
    v_exp_f32 v2, v2
    v_exp_f32 v3, v3
    v_exp_f32 v4, v4
    v_cvt_pk_bf16_f32 v34, v2, v3
    v_exp_f32 v5, v5
    v_exp_f32 v6, v6
    v_cvt_pk_bf16_f32 v35, v4, v5
    v_mfma_f32_32x32x16_bf16 v[42:57], v[86:89], v[38:41], v[42:57]
    ds_read_b128 v[106:109], v120 offset:50176
    v_exp_f32 v7, v7
    v_exp_f32 v8, v8
    v_cvt_pk_bf16_f32 v36, v6, v7
    v_exp_f32 v9, v9
    v_exp_f32 v10, v10
    v_cvt_pk_bf16_f32 v37, v8, v9
    v_mfma_f32_32x32x16_bf16 v[18:33], v[90:93], v[78:81], v[18:33]
    ds_read_b128 v[102:105], v120 offset:35840
    ds_read_b128 v[110:113], v120 offset:38912
    v_exp_f32 v11, v11
    v_exp_f32 v12, v12
    v_cvt_pk_bf16_f32 v38, v10, v11
    v_exp_f32 v13, v13
    v_exp_f32 v14, v14
    v_cvt_pk_bf16_f32 v39, v12, v13
    v_mfma_f32_32x32x16_bf16 v[42:57], v[94:97], v[34:37], v[42:57]
    s_add_u32 m0, s49, 16384
    s_nop 0
    buffer_load_dwordx4 v115, s[36:39], s48 offen offset:0 sc1 lds
    v_exp_f32 v15, v15
    v_exp_f32 v16, v16
    v_cvt_pk_bf16_f32 v40, v14, v15
    v_exp_f32 v17, v17
    s_waitcnt lgkmcnt(0)
    v_cvt_pk_bf16_f32 v41, v16, v17
    v_mfma_f32_32x32x16_bf16 v[2:17], v[98:101], v[74:77], v[58:73]
    ds_read_b128 v[82:85], v120 offset:53248
    v_exp_f32 v18, v18
    v_exp_f32 v19, v19
    v_exp_f32 v20, v20
    v_cvt_pk_bf16_f32 v34, v18, v19
    v_exp_f32 v21, v21
    v_exp_f32 v22, v22
    v_cvt_pk_bf16_f32 v35, v20, v21
    v_mfma_f32_32x32x16_bf16 v[42:57], v[102:105], v[38:41], v[42:57]
    ds_read_b128 v[90:93], v120 offset:54272
    v_exp_f32 v23, v23
    v_exp_f32 v24, v24
    v_cvt_pk_bf16_f32 v36, v22, v23
    v_exp_f32 v25, v25
    v_exp_f32 v26, v26
    v_cvt_pk_bf16_f32 v37, v24, v25
    v_mfma_f32_32x32x16_bf16 v[2:17], v[106:109], v[78:81], v[2:17]
    ds_read_b128 v[86:89], v120 offset:39936
    ds_read_b128 v[94:97], v120 offset:51200
    v_exp_f32 v27, v27
    v_exp_f32 v28, v28
    v_cvt_pk_bf16_f32 v38, v26, v27
    v_exp_f32 v29, v29
    v_exp_f32 v30, v30
    v_cvt_pk_bf16_f32 v39, v28, v29
    v_mfma_f32_32x32x16_bf16 v[42:57], v[110:113], v[34:37], v[42:57]
    buffer_load_dwordx4 v115, s[36:39], s48 offen offset:1024 sc1 lds
    s_add_u32 s59, s59, 16384
    s_and_b32 s59, s59, 0x3ffff
    s_add_u32 s48, s58, s59
    v_exp_f32 v31, v31
    v_exp_f32 v32, v32
    v_cvt_pk_bf16_f32 v40, v30, v31
    v_exp_f32 v33, v33
    s_waitcnt lgkmcnt(0)
    v_cvt_pk_bf16_f32 v41, v32, v33
    s_waitcnt vmcnt(2)
    s_barrier
    v_mfma_f32_32x32x16_bf16 v[18:33], v[82:85], v[74:77], v[58:73]
    ds_read_b128 v[98:101], v120 offset:0
    v_exp_f32 v2, v2
    v_exp_f32 v3, v3
    v_exp_f32 v4, v4
    v_cvt_pk_bf16_f32 v34, v2, v3
    v_exp_f32 v5, v5
    v_exp_f32 v6, v6
    v_cvt_pk_bf16_f32 v35, v4, v5
    v_mfma_f32_32x32x16_bf16 v[42:57], v[86:89], v[38:41], v[42:57]
    ds_read_b128 v[106:109], v120 offset:1024
    v_exp_f32 v7, v7
    v_exp_f32 v8, v8
    v_cvt_pk_bf16_f32 v36, v6, v7
    v_exp_f32 v9, v9
    v_exp_f32 v10, v10
    v_cvt_pk_bf16_f32 v37, v8, v9
    v_mfma_f32_32x32x16_bf16 v[18:33], v[90:93], v[78:81], v[18:33]
    ds_read_b128 v[102:105], v120 offset:52224
    ds_read_b128 v[110:113], v120 offset:55296
    v_exp_f32 v11, v11
    v_exp_f32 v12, v12
    v_cvt_pk_bf16_f32 v38, v10, v11
    v_exp_f32 v13, v13
    v_exp_f32 v14, v14
    v_cvt_pk_bf16_f32 v39, v12, v13
    v_mfma_f32_32x32x16_bf16 v[42:57], v[94:97], v[34:37], v[42:57]
    s_add_u32 m0, s49, 32768
    s_nop 0
    buffer_load_dwordx4 v115, s[36:39], s48 offen offset:0 sc1 lds
    v_exp_f32 v15, v15
    v_exp_f32 v16, v16
    v_cvt_pk_bf16_f32 v40, v14, v15
    v_exp_f32 v17, v17
    s_waitcnt lgkmcnt(0)
    v_cvt_pk_bf16_f32 v41, v16, v17
    v_mfma_f32_32x32x16_bf16 v[2:17], v[98:101], v[74:77], v[58:73]
    ds_read_b128 v[82:85], v120 offset:4096
    v_exp_f32 v18, v18
    v_exp_f32 v19, v19
    v_exp_f32 v20, v20
    v_cvt_pk_bf16_f32 v34, v18, v19
    v_exp_f32 v21, v21
    v_exp_f32 v22, v22
    v_cvt_pk_bf16_f32 v35, v20, v21
    v_mfma_f32_32x32x16_bf16 v[42:57], v[102:105], v[38:41], v[42:57]
    ds_read_b128 v[90:93], v120 offset:5120
    v_exp_f32 v23, v23
    v_exp_f32 v24, v24
    v_cvt_pk_bf16_f32 v36, v22, v23
    v_exp_f32 v25, v25
    v_exp_f32 v26, v26
    v_cvt_pk_bf16_f32 v37, v24, v25
    v_mfma_f32_32x32x16_bf16 v[2:17], v[106:109], v[78:81], v[2:17]
    ds_read_b128 v[86:89], v120 offset:56320
    ds_read_b128 v[94:97], v120 offset:2048
    v_exp_f32 v27, v27
    v_exp_f32 v28, v28
    v_cvt_pk_bf16_f32 v38, v26, v27
    v_exp_f32 v29, v29
    v_exp_f32 v30, v30
    v_cvt_pk_bf16_f32 v39, v28, v29
    v_mfma_f32_32x32x16_bf16 v[42:57], v[110:113], v[34:37], v[42:57]
    buffer_load_dwordx4 v115, s[36:39], s48 offen offset:1024 sc1 lds
    s_add_u32 s59, s59, 16384
    s_and_b32 s59, s59, 0x3ffff
    s_add_u32 s48, s58, s59
    v_exp_f32 v31, v31
    v_exp_f32 v32, v32
    v_cvt_pk_bf16_f32 v40, v30, v31
    v_exp_f32 v33, v33
    s_waitcnt lgkmcnt(0)
    v_cvt_pk_bf16_f32 v41, v32, v33
    s_waitcnt vmcnt(2)
    s_barrier
    v_mfma_f32_32x32x16_bf16 v[18:33], v[82:85], v[74:77], v[58:73]
    ds_read_b128 v[98:101], v120 offset:16384
    v_exp_f32 v2, v2
    v_exp_f32 v3, v3
    v_exp_f32 v4, v4
    v_cvt_pk_bf16_f32 v34, v2, v3
    v_exp_f32 v5, v5
    v_exp_f32 v6, v6
    v_cvt_pk_bf16_f32 v35, v4, v5
    v_mfma_f32_32x32x16_bf16 v[42:57], v[86:89], v[38:41], v[42:57]
    ds_read_b128 v[106:109], v120 offset:17408
    v_exp_f32 v7, v7
    v_exp_f32 v8, v8
    v_cvt_pk_bf16_f32 v36, v6, v7
    v_exp_f32 v9, v9
    v_exp_f32 v10, v10
    v_cvt_pk_bf16_f32 v37, v8, v9
    v_mfma_f32_32x32x16_bf16 v[18:33], v[90:93], v[78:81], v[18:33]
    ds_read_b128 v[102:105], v120 offset:3072
    ds_read_b128 v[110:113], v120 offset:6144
    v_exp_f32 v11, v11
    v_exp_f32 v12, v12
    v_cvt_pk_bf16_f32 v38, v10, v11
    v_exp_f32 v13, v13
    v_exp_f32 v14, v14
    v_cvt_pk_bf16_f32 v39, v12, v13
    v_mfma_f32_32x32x16_bf16 v[42:57], v[94:97], v[34:37], v[42:57]
    s_add_u32 m0, s49, 49152
    s_nop 0
    buffer_load_dwordx4 v115, s[36:39], s48 offen offset:0 sc1 lds
    v_exp_f32 v15, v15
    v_exp_f32 v16, v16
    v_cvt_pk_bf16_f32 v40, v14, v15
    v_exp_f32 v17, v17
    s_waitcnt lgkmcnt(0)
    v_cvt_pk_bf16_f32 v41, v16, v17
    v_mfma_f32_32x32x16_bf16 v[2:17], v[98:101], v[74:77], v[58:73]
    ds_read_b128 v[82:85], v120 offset:20480
    v_exp_f32 v18, v18
    v_exp_f32 v19, v19
    v_exp_f32 v20, v20
    v_cvt_pk_bf16_f32 v34, v18, v19
    v_exp_f32 v21, v21
    v_exp_f32 v22, v22
    v_cvt_pk_bf16_f32 v35, v20, v21
    v_mfma_f32_32x32x16_bf16 v[42:57], v[102:105], v[38:41], v[42:57]
    ds_read_b128 v[90:93], v120 offset:21504
    v_exp_f32 v23, v23
    v_exp_f32 v24, v24
    v_cvt_pk_bf16_f32 v36, v22, v23
    v_exp_f32 v25, v25
    v_exp_f32 v26, v26
    v_cvt_pk_bf16_f32 v37, v24, v25
    v_mfma_f32_32x32x16_bf16 v[2:17], v[106:109], v[78:81], v[2:17]
    ds_read_b128 v[86:89], v120 offset:7168
    ds_read_b128 v[94:97], v120 offset:18432
    v_exp_f32 v27, v27
    v_exp_f32 v28, v28
    v_cvt_pk_bf16_f32 v38, v26, v27
    v_exp_f32 v29, v29
    v_exp_f32 v30, v30
    v_cvt_pk_bf16_f32 v39, v28, v29
    v_mfma_f32_32x32x16_bf16 v[42:57], v[110:113], v[34:37], v[42:57]
    buffer_load_dwordx4 v115, s[36:39], s48 offen offset:1024 sc1 lds
    s_add_u32 s59, s59, 16384
    s_and_b32 s59, s59, 0x3ffff
    s_add_u32 s48, s58, s59
    v_exp_f32 v31, v31
    v_exp_f32 v32, v32
    v_cvt_pk_bf16_f32 v40, v30, v31
    v_exp_f32 v33, v33
    s_waitcnt lgkmcnt(0)
    v_cvt_pk_bf16_f32 v41, v32, v33
    s_waitcnt vmcnt(2)
    s_barrier
    v_mfma_f32_32x32x16_bf16 v[18:33], v[82:85], v[74:77], v[58:73]
    ds_read_b128 v[98:101], v120 offset:32768
    v_exp_f32 v2, v2
    v_exp_f32 v3, v3
    v_exp_f32 v4, v4
    v_cvt_pk_bf16_f32 v34, v2, v3
    v_exp_f32 v5, v5
    v_exp_f32 v6, v6
    v_cvt_pk_bf16_f32 v35, v4, v5
    v_mfma_f32_32x32x16_bf16 v[42:57], v[86:89], v[38:41], v[42:57]
    ds_read_b128 v[106:109], v120 offset:33792
    v_exp_f32 v7, v7
    v_exp_f32 v8, v8
    v_cvt_pk_bf16_f32 v36, v6, v7
    v_exp_f32 v9, v9
    v_exp_f32 v10, v10
    v_cvt_pk_bf16_f32 v37, v8, v9
    v_mfma_f32_32x32x16_bf16 v[18:33], v[90:93], v[78:81], v[18:33]
    ds_read_b128 v[102:105], v120 offset:19456
    ds_read_b128 v[110:113], v120 offset:22528
    v_exp_f32 v11, v11
    v_exp_f32 v12, v12
    v_cvt_pk_bf16_f32 v38, v10, v11
    v_exp_f32 v13, v13
    v_exp_f32 v14, v14
    v_cvt_pk_bf16_f32 v39, v12, v13
    v_mfma_f32_32x32x16_bf16 v[42:57], v[94:97], v[34:37], v[42:57]
    s_add_u32 m0, s49, 0
    s_nop 0
    buffer_load_dwordx4 v115, s[36:39], s48 offen offset:0 sc1 lds
    v_exp_f32 v15, v15
    v_exp_f32 v16, v16
    v_cvt_pk_bf16_f32 v40, v14, v15
    v_exp_f32 v17, v17
    s_waitcnt lgkmcnt(0)
    v_cvt_pk_bf16_f32 v41, v16, v17
    v_mfma_f32_32x32x16_bf16 v[2:17], v[98:101], v[74:77], v[58:73]
    ds_read_b128 v[82:85], v120 offset:36864
    v_exp_f32 v18, v18
    v_exp_f32 v19, v19
    v_exp_f32 v20, v20
    v_cvt_pk_bf16_f32 v34, v18, v19
    v_exp_f32 v21, v21
    v_exp_f32 v22, v22
    v_cvt_pk_bf16_f32 v35, v20, v21
    v_mfma_f32_32x32x16_bf16 v[42:57], v[102:105], v[38:41], v[42:57]
    ds_read_b128 v[90:93], v120 offset:37888
    v_exp_f32 v23, v23
    v_exp_f32 v24, v24
    v_cvt_pk_bf16_f32 v36, v22, v23
    v_exp_f32 v25, v25
    v_exp_f32 v26, v26
    v_cvt_pk_bf16_f32 v37, v24, v25
    v_mfma_f32_32x32x16_bf16 v[2:17], v[106:109], v[78:81], v[2:17]
    ds_read_b128 v[86:89], v120 offset:23552
    ds_read_b128 v[94:97], v120 offset:34816
    v_exp_f32 v27, v27
    v_exp_f32 v28, v28
    v_cvt_pk_bf16_f32 v38, v26, v27
    v_exp_f32 v29, v29
    v_exp_f32 v30, v30
    v_cvt_pk_bf16_f32 v39, v28, v29
    v_mfma_f32_32x32x16_bf16 v[42:57], v[110:113], v[34:37], v[42:57]
    buffer_load_dwordx4 v115, s[36:39], s48 offen offset:1024 sc1 lds
    s_add_u32 s59, s59, 16384
    s_and_b32 s59, s59, 0x3ffff
    s_add_u32 s48, s58, s59
    v_exp_f32 v31, v31
    v_exp_f32 v32, v32
    v_cvt_pk_bf16_f32 v40, v30, v31
    v_exp_f32 v33, v33
    s_waitcnt lgkmcnt(0)
    v_cvt_pk_bf16_f32 v41, v32, v33
    s_waitcnt vmcnt(2)
    s_barrier
    v_mfma_f32_32x32x16_bf16 v[18:33], v[82:85], v[74:77], v[58:73]
    ds_read_b128 v[98:101], v120 offset:49152
    v_exp_f32 v2, v2
    v_exp_f32 v3, v3
    v_exp_f32 v4, v4
    v_cvt_pk_bf16_f32 v34, v2, v3
    v_exp_f32 v5, v5
    v_exp_f32 v6, v6
    v_cvt_pk_bf16_f32 v35, v4, v5
    v_mfma_f32_32x32x16_bf16 v[42:57], v[86:89], v[38:41], v[42:57]
    ds_read_b128 v[106:109], v120 offset:50176
    v_exp_f32 v7, v7
    v_exp_f32 v8, v8
    v_cvt_pk_bf16_f32 v36, v6, v7
    v_exp_f32 v9, v9
    v_exp_f32 v10, v10
    v_cvt_pk_bf16_f32 v37, v8, v9
    v_mfma_f32_32x32x16_bf16 v[18:33], v[90:93], v[78:81], v[18:33]
    ds_read_b128 v[102:105], v120 offset:35840
    ds_read_b128 v[110:113], v120 offset:38912
    v_exp_f32 v11, v11
    v_exp_f32 v12, v12
    v_cvt_pk_bf16_f32 v38, v10, v11
    v_exp_f32 v13, v13
    v_exp_f32 v14, v14
    v_cvt_pk_bf16_f32 v39, v12, v13
    v_mfma_f32_32x32x16_bf16 v[42:57], v[94:97], v[34:37], v[42:57]
    s_add_u32 m0, s49, 16384
    s_nop 0
    buffer_load_dwordx4 v115, s[36:39], s48 offen offset:0 sc1 lds
    v_exp_f32 v15, v15
    v_exp_f32 v16, v16
    v_cvt_pk_bf16_f32 v40, v14, v15
    v_exp_f32 v17, v17
    s_waitcnt lgkmcnt(0)
    v_cvt_pk_bf16_f32 v41, v16, v17
    v_mfma_f32_32x32x16_bf16 v[2:17], v[98:101], v[74:77], v[58:73]
    ds_read_b128 v[82:85], v120 offset:53248
    v_exp_f32 v18, v18
    v_exp_f32 v19, v19
    v_exp_f32 v20, v20
    v_cvt_pk_bf16_f32 v34, v18, v19
    v_exp_f32 v21, v21
    v_exp_f32 v22, v22
    v_cvt_pk_bf16_f32 v35, v20, v21
    v_mfma_f32_32x32x16_bf16 v[42:57], v[102:105], v[38:41], v[42:57]
    ds_read_b128 v[90:93], v120 offset:54272
    v_exp_f32 v23, v23
    v_exp_f32 v24, v24
    v_cvt_pk_bf16_f32 v36, v22, v23
    v_exp_f32 v25, v25
    v_exp_f32 v26, v26
    v_cvt_pk_bf16_f32 v37, v24, v25
    v_mfma_f32_32x32x16_bf16 v[2:17], v[106:109], v[78:81], v[2:17]
    ds_read_b128 v[86:89], v120 offset:39936
    ds_read_b128 v[94:97], v120 offset:51200
    v_exp_f32 v27, v27
    v_exp_f32 v28, v28
    v_cvt_pk_bf16_f32 v38, v26, v27
    v_exp_f32 v29, v29
    v_exp_f32 v30, v30
    v_cvt_pk_bf16_f32 v39, v28, v29
    v_mfma_f32_32x32x16_bf16 v[42:57], v[110:113], v[34:37], v[42:57]
    buffer_load_dwordx4 v115, s[36:39], s48 offen offset:1024 sc1 lds
    s_add_u32 s59, s59, 16384
    s_and_b32 s59, s59, 0x3ffff
    s_add_u32 s48, s58, s59
    v_exp_f32 v31, v31
    v_exp_f32 v32, v32
    v_cvt_pk_bf16_f32 v40, v30, v31
    v_exp_f32 v33, v33
    s_waitcnt lgkmcnt(0)
    v_cvt_pk_bf16_f32 v41, v32, v33
    s_waitcnt vmcnt(2)
    s_barrier
    v_mfma_f32_32x32x16_bf16 v[18:33], v[82:85], v[74:77], v[58:73]
    ds_read_b128 v[98:101], v120 offset:0
    v_exp_f32 v2, v2
    v_exp_f32 v3, v3
    v_exp_f32 v4, v4
    v_cvt_pk_bf16_f32 v34, v2, v3
    v_exp_f32 v5, v5
    v_exp_f32 v6, v6
    v_cvt_pk_bf16_f32 v35, v4, v5
    v_mfma_f32_32x32x16_bf16 v[42:57], v[86:89], v[38:41], v[42:57]
    ds_read_b128 v[106:109], v120 offset:1024
    v_exp_f32 v7, v7
    v_exp_f32 v8, v8
    v_cvt_pk_bf16_f32 v36, v6, v7
    v_exp_f32 v9, v9
    v_exp_f32 v10, v10
    v_cvt_pk_bf16_f32 v37, v8, v9
    v_mfma_f32_32x32x16_bf16 v[18:33], v[90:93], v[78:81], v[18:33]
    ds_read_b128 v[102:105], v120 offset:52224
    ds_read_b128 v[110:113], v120 offset:55296
    v_exp_f32 v11, v11
    v_exp_f32 v12, v12
    v_cvt_pk_bf16_f32 v38, v10, v11
    v_exp_f32 v13, v13
    v_exp_f32 v14, v14
    v_cvt_pk_bf16_f32 v39, v12, v13
    v_mfma_f32_32x32x16_bf16 v[42:57], v[94:97], v[34:37], v[42:57]
    s_add_u32 m0, s49, 32768
    s_nop 0
    buffer_load_dwordx4 v115, s[36:39], s48 offen offset:0 sc1 lds
    v_exp_f32 v15, v15
    v_exp_f32 v16, v16
    v_cvt_pk_bf16_f32 v40, v14, v15
    v_exp_f32 v17, v17
    s_waitcnt lgkmcnt(0)
    v_cvt_pk_bf16_f32 v41, v16, v17
    v_mfma_f32_32x32x16_bf16 v[2:17], v[98:101], v[74:77], v[58:73]
    ds_read_b128 v[82:85], v120 offset:4096
    v_exp_f32 v18, v18
    v_exp_f32 v19, v19
    v_exp_f32 v20, v20
    v_cvt_pk_bf16_f32 v34, v18, v19
    v_exp_f32 v21, v21
    v_exp_f32 v22, v22
    v_cvt_pk_bf16_f32 v35, v20, v21
    v_mfma_f32_32x32x16_bf16 v[42:57], v[102:105], v[38:41], v[42:57]
    ds_read_b128 v[90:93], v120 offset:5120
    v_exp_f32 v23, v23
    v_exp_f32 v24, v24
    v_cvt_pk_bf16_f32 v36, v22, v23
    v_exp_f32 v25, v25
    v_exp_f32 v26, v26
    v_cvt_pk_bf16_f32 v37, v24, v25
    v_mfma_f32_32x32x16_bf16 v[2:17], v[106:109], v[78:81], v[2:17]
    ds_read_b128 v[86:89], v120 offset:56320
    ds_read_b128 v[94:97], v120 offset:2048
    v_exp_f32 v27, v27
    v_exp_f32 v28, v28
    v_cvt_pk_bf16_f32 v38, v26, v27
    v_exp_f32 v29, v29
    v_exp_f32 v30, v30
    v_cvt_pk_bf16_f32 v39, v28, v29
    v_mfma_f32_32x32x16_bf16 v[42:57], v[110:113], v[34:37], v[42:57]
    buffer_load_dwordx4 v115, s[36:39], s48 offen offset:1024 sc1 lds
    s_add_u32 s59, s59, 16384
    s_and_b32 s59, s59, 0x3ffff
    s_add_u32 s48, s58, s59
    v_exp_f32 v31, v31
    v_exp_f32 v32, v32
    v_cvt_pk_bf16_f32 v40, v30, v31
    v_exp_f32 v33, v33
    s_waitcnt lgkmcnt(0)
    v_cvt_pk_bf16_f32 v41, v32, v33
    s_waitcnt vmcnt(2)
    s_barrier
    v_mfma_f32_32x32x16_bf16 v[18:33], v[82:85], v[74:77], v[58:73]
    ds_read_b128 v[98:101], v120 offset:16384
    v_exp_f32 v2, v2
    v_exp_f32 v3, v3
    v_exp_f32 v4, v4
    v_cvt_pk_bf16_f32 v34, v2, v3
    v_exp_f32 v5, v5
    v_exp_f32 v6, v6
    v_cvt_pk_bf16_f32 v35, v4, v5
    v_mfma_f32_32x32x16_bf16 v[42:57], v[86:89], v[38:41], v[42:57]
    ds_read_b128 v[106:109], v120 offset:17408
    v_exp_f32 v7, v7
    v_exp_f32 v8, v8
    v_cvt_pk_bf16_f32 v36, v6, v7
    v_exp_f32 v9, v9
    v_exp_f32 v10, v10
    v_cvt_pk_bf16_f32 v37, v8, v9
    v_mfma_f32_32x32x16_bf16 v[18:33], v[90:93], v[78:81], v[18:33]
    ds_read_b128 v[102:105], v120 offset:3072
    ds_read_b128 v[110:113], v120 offset:6144
    v_exp_f32 v11, v11
    v_exp_f32 v12, v12
    v_cvt_pk_bf16_f32 v38, v10, v11
    v_exp_f32 v13, v13
    v_exp_f32 v14, v14
    v_cvt_pk_bf16_f32 v39, v12, v13
    v_mfma_f32_32x32x16_bf16 v[42:57], v[94:97], v[34:37], v[42:57]
    s_add_u32 m0, s49, 49152
    s_nop 0
    buffer_load_dwordx4 v115, s[36:39], s48 offen offset:0 sc1 lds
    v_exp_f32 v15, v15
    v_exp_f32 v16, v16
    v_cvt_pk_bf16_f32 v40, v14, v15
    v_exp_f32 v17, v17
    s_waitcnt lgkmcnt(0)
    v_cvt_pk_bf16_f32 v41, v16, v17
    v_mfma_f32_32x32x16_bf16 v[2:17], v[98:101], v[74:77], v[58:73]
    ds_read_b128 v[82:85], v120 offset:20480
    v_exp_f32 v18, v18
    v_exp_f32 v19, v19
    v_exp_f32 v20, v20
    v_cvt_pk_bf16_f32 v34, v18, v19
    v_exp_f32 v21, v21
    v_exp_f32 v22, v22
    v_cvt_pk_bf16_f32 v35, v20, v21
    v_mfma_f32_32x32x16_bf16 v[42:57], v[102:105], v[38:41], v[42:57]
    ds_read_b128 v[90:93], v120 offset:21504
    v_exp_f32 v23, v23
    v_exp_f32 v24, v24
    v_cvt_pk_bf16_f32 v36, v22, v23
    v_exp_f32 v25, v25
    v_exp_f32 v26, v26
    v_cvt_pk_bf16_f32 v37, v24, v25
    v_mfma_f32_32x32x16_bf16 v[2:17], v[106:109], v[78:81], v[2:17]
    ds_read_b128 v[86:89], v120 offset:7168
    ds_read_b128 v[94:97], v120 offset:18432
    v_exp_f32 v27, v27
    v_exp_f32 v28, v28
    v_cvt_pk_bf16_f32 v38, v26, v27
    v_exp_f32 v29, v29
    v_exp_f32 v30, v30
    v_cvt_pk_bf16_f32 v39, v28, v29
    v_mfma_f32_32x32x16_bf16 v[42:57], v[110:113], v[34:37], v[42:57]
    buffer_load_dwordx4 v115, s[36:39], s48 offen offset:1024 sc1 lds
    s_add_u32 s59, s59, 16384
    s_and_b32 s59, s59, 0x3ffff
    s_add_u32 s48, s58, s59
    v_exp_f32 v31, v31
    v_exp_f32 v32, v32
    v_cvt_pk_bf16_f32 v40, v30, v31
    v_exp_f32 v33, v33
    s_waitcnt lgkmcnt(0)
    v_cvt_pk_bf16_f32 v41, v32, v33
    s_waitcnt vmcnt(2)
    s_barrier
    v_mfma_f32_32x32x16_bf16 v[18:33], v[82:85], v[74:77], v[58:73]
    ds_read_b128 v[98:101], v120 offset:32768
    v_exp_f32 v2, v2
    v_exp_f32 v3, v3
    v_exp_f32 v4, v4
    v_cvt_pk_bf16_f32 v34, v2, v3
    v_exp_f32 v5, v5
    v_exp_f32 v6, v6
    v_cvt_pk_bf16_f32 v35, v4, v5
    v_mfma_f32_32x32x16_bf16 v[42:57], v[86:89], v[38:41], v[42:57]
    ds_read_b128 v[106:109], v120 offset:33792
    v_exp_f32 v7, v7
    v_exp_f32 v8, v8
    v_cvt_pk_bf16_f32 v36, v6, v7
    v_exp_f32 v9, v9
    v_exp_f32 v10, v10
    v_cvt_pk_bf16_f32 v37, v8, v9
    v_mfma_f32_32x32x16_bf16 v[18:33], v[90:93], v[78:81], v[18:33]
    ds_read_b128 v[102:105], v120 offset:19456
    ds_read_b128 v[110:113], v120 offset:22528
    v_exp_f32 v11, v11
    v_exp_f32 v12, v12
    v_cvt_pk_bf16_f32 v38, v10, v11
    v_exp_f32 v13, v13
    v_exp_f32 v14, v14
    v_cvt_pk_bf16_f32 v39, v12, v13
    v_mfma_f32_32x32x16_bf16 v[42:57], v[94:97], v[34:37], v[42:57]
    s_add_u32 m0, s49, 0
    s_nop 0
    buffer_load_dwordx4 v115, s[36:39], s48 offen offset:0 sc1 lds
    v_exp_f32 v15, v15
    v_exp_f32 v16, v16
    v_cvt_pk_bf16_f32 v40, v14, v15
    v_exp_f32 v17, v17
    s_waitcnt lgkmcnt(0)
    v_cvt_pk_bf16_f32 v41, v16, v17
    v_mfma_f32_32x32x16_bf16 v[2:17], v[98:101], v[74:77], v[58:73]
    ds_read_b128 v[82:85], v120 offset:36864
    v_exp_f32 v18, v18
    v_exp_f32 v19, v19
    v_exp_f32 v20, v20
    v_cvt_pk_bf16_f32 v34, v18, v19
    v_exp_f32 v21, v21
    v_exp_f32 v22, v22
    v_cvt_pk_bf16_f32 v35, v20, v21
    v_mfma_f32_32x32x16_bf16 v[42:57], v[102:105], v[38:41], v[42:57]
    ds_read_b128 v[90:93], v120 offset:37888
    v_exp_f32 v23, v23
    v_exp_f32 v24, v24
    v_cvt_pk_bf16_f32 v36, v22, v23
    v_exp_f32 v25, v25
    v_exp_f32 v26, v26
    v_cvt_pk_bf16_f32 v37, v24, v25
    v_mfma_f32_32x32x16_bf16 v[2:17], v[106:109], v[78:81], v[2:17]
    ds_read_b128 v[86:89], v120 offset:23552
    ds_read_b128 v[94:97], v120 offset:34816
    v_exp_f32 v27, v27
    v_exp_f32 v28, v28
    v_cvt_pk_bf16_f32 v38, v26, v27
    v_exp_f32 v29, v29
    v_exp_f32 v30, v30
    v_cvt_pk_bf16_f32 v39, v28, v29
    v_mfma_f32_32x32x16_bf16 v[42:57], v[110:113], v[34:37], v[42:57]
    buffer_load_dwordx4 v115, s[36:39], s48 offen offset:1024 sc1 lds
    s_add_u32 s59, s59, 16384
    s_and_b32 s59, s59, 0x3ffff
    s_add_u32 s48, s58, s59
    v_exp_f32 v31, v31
    v_exp_f32 v32, v32
    v_cvt_pk_bf16_f32 v40, v30, v31
    v_exp_f32 v33, v33
    s_waitcnt lgkmcnt(0)
    v_cvt_pk_bf16_f32 v41, v32, v33
    s_waitcnt vmcnt(2)
    s_barrier
    v_mfma_f32_32x32x16_bf16 v[18:33], v[82:85], v[74:77], v[58:73]
    ds_read_b128 v[98:101], v120 offset:49152
    v_exp_f32 v2, v2
    v_exp_f32 v3, v3
    v_exp_f32 v4, v4
    v_cvt_pk_bf16_f32 v34, v2, v3
    v_exp_f32 v5, v5
    v_exp_f32 v6, v6
    v_cvt_pk_bf16_f32 v35, v4, v5
    v_mfma_f32_32x32x16_bf16 v[42:57], v[86:89], v[38:41], v[42:57]
    ds_read_b128 v[106:109], v120 offset:50176
    v_exp_f32 v7, v7
    v_exp_f32 v8, v8
    v_cvt_pk_bf16_f32 v36, v6, v7
    v_exp_f32 v9, v9
    v_exp_f32 v10, v10
    v_cvt_pk_bf16_f32 v37, v8, v9
    v_mfma_f32_32x32x16_bf16 v[18:33], v[90:93], v[78:81], v[18:33]
    ds_read_b128 v[102:105], v120 offset:35840
    ds_read_b128 v[110:113], v120 offset:38912
    v_exp_f32 v11, v11
    v_exp_f32 v12, v12
    v_cvt_pk_bf16_f32 v38, v10, v11
    v_exp_f32 v13, v13
    v_exp_f32 v14, v14
    v_cvt_pk_bf16_f32 v39, v12, v13
    v_mfma_f32_32x32x16_bf16 v[42:57], v[94:97], v[34:37], v[42:57]
    s_add_u32 m0, s49, 16384
    s_nop 0
    buffer_load_dwordx4 v115, s[36:39], s48 offen offset:0 sc1 lds
    v_exp_f32 v15, v15
    v_exp_f32 v16, v16
    v_cvt_pk_bf16_f32 v40, v14, v15
    v_exp_f32 v17, v17
    s_waitcnt lgkmcnt(0)
    v_cvt_pk_bf16_f32 v41, v16, v17
    v_mfma_f32_32x32x16_bf16 v[2:17], v[98:101], v[74:77], v[58:73]
    ds_read_b128 v[82:85], v120 offset:53248
    v_exp_f32 v18, v18
    v_exp_f32 v19, v19
    v_exp_f32 v20, v20
    v_cvt_pk_bf16_f32 v34, v18, v19
    v_exp_f32 v21, v21
    v_exp_f32 v22, v22
    v_cvt_pk_bf16_f32 v35, v20, v21
    v_mfma_f32_32x32x16_bf16 v[42:57], v[102:105], v[38:41], v[42:57]
    ds_read_b128 v[90:93], v120 offset:54272
    v_exp_f32 v23, v23
    v_exp_f32 v24, v24
    v_cvt_pk_bf16_f32 v36, v22, v23
    v_exp_f32 v25, v25
    v_exp_f32 v26, v26
    v_cvt_pk_bf16_f32 v37, v24, v25
    v_mfma_f32_32x32x16_bf16 v[2:17], v[106:109], v[78:81], v[2:17]
    ds_read_b128 v[86:89], v120 offset:39936
    ds_read_b128 v[94:97], v120 offset:51200
    v_exp_f32 v27, v27
    v_exp_f32 v28, v28
    v_cvt_pk_bf16_f32 v38, v26, v27
    v_exp_f32 v29, v29
    v_exp_f32 v30, v30
    v_cvt_pk_bf16_f32 v39, v28, v29
    v_mfma_f32_32x32x16_bf16 v[42:57], v[110:113], v[34:37], v[42:57]
    buffer_load_dwordx4 v115, s[36:39], s48 offen offset:1024 sc1 lds
    s_add_u32 s59, s59, 16384
    s_and_b32 s59, s59, 0x3ffff
    s_add_u32 s48, s58, s59
    v_exp_f32 v31, v31
    v_exp_f32 v32, v32
    v_cvt_pk_bf16_f32 v40, v30, v31
    v_exp_f32 v33, v33
    s_waitcnt lgkmcnt(0)
    v_cvt_pk_bf16_f32 v41, v32, v33
    s_waitcnt vmcnt(2)
    s_barrier
    v_mfma_f32_32x32x16_bf16 v[18:33], v[82:85], v[74:77], v[58:73]
    ds_read_b128 v[98:101], v120 offset:0
    v_exp_f32 v2, v2
    v_exp_f32 v3, v3
    v_exp_f32 v4, v4
    v_cvt_pk_bf16_f32 v34, v2, v3
    v_exp_f32 v5, v5
    v_exp_f32 v6, v6
    v_cvt_pk_bf16_f32 v35, v4, v5
    v_mfma_f32_32x32x16_bf16 v[42:57], v[86:89], v[38:41], v[42:57]
    ds_read_b128 v[106:109], v120 offset:1024
    v_exp_f32 v7, v7
    v_exp_f32 v8, v8
    v_cvt_pk_bf16_f32 v36, v6, v7
    v_exp_f32 v9, v9
    v_exp_f32 v10, v10
    v_cvt_pk_bf16_f32 v37, v8, v9
    v_mfma_f32_32x32x16_bf16 v[18:33], v[90:93], v[78:81], v[18:33]
    ds_read_b128 v[102:105], v120 offset:52224
    ds_read_b128 v[110:113], v120 offset:55296
    v_exp_f32 v11, v11
    v_exp_f32 v12, v12
    v_cvt_pk_bf16_f32 v38, v10, v11
    v_exp_f32 v13, v13
    v_exp_f32 v14, v14
    v_cvt_pk_bf16_f32 v39, v12, v13
    v_mfma_f32_32x32x16_bf16 v[42:57], v[94:97], v[34:37], v[42:57]
    s_add_u32 m0, s49, 32768
    s_nop 0
    buffer_load_dwordx4 v115, s[36:39], s48 offen offset:0 sc1 lds
    v_exp_f32 v15, v15
    v_exp_f32 v16, v16
    v_cvt_pk_bf16_f32 v40, v14, v15
    v_exp_f32 v17, v17
    s_waitcnt lgkmcnt(0)
    v_cvt_pk_bf16_f32 v41, v16, v17
    v_mfma_f32_32x32x16_bf16 v[2:17], v[98:101], v[74:77], v[58:73]
    ds_read_b128 v[82:85], v120 offset:4096
    v_exp_f32 v18, v18
    v_exp_f32 v19, v19
    v_exp_f32 v20, v20
    v_cvt_pk_bf16_f32 v34, v18, v19
    v_exp_f32 v21, v21
    v_exp_f32 v22, v22
    v_cvt_pk_bf16_f32 v35, v20, v21
    v_mfma_f32_32x32x16_bf16 v[42:57], v[102:105], v[38:41], v[42:57]
    ds_read_b128 v[90:93], v120 offset:5120
    v_exp_f32 v23, v23
    v_exp_f32 v24, v24
    v_cvt_pk_bf16_f32 v36, v22, v23
    v_exp_f32 v25, v25
    v_exp_f32 v26, v26
    v_cvt_pk_bf16_f32 v37, v24, v25
    v_mfma_f32_32x32x16_bf16 v[2:17], v[106:109], v[78:81], v[2:17]
    ds_read_b128 v[86:89], v120 offset:56320
    ds_read_b128 v[94:97], v120 offset:2048
    v_exp_f32 v27, v27
    v_exp_f32 v28, v28
    v_cvt_pk_bf16_f32 v38, v26, v27
    v_exp_f32 v29, v29
    v_exp_f32 v30, v30
    v_cvt_pk_bf16_f32 v39, v28, v29
    v_mfma_f32_32x32x16_bf16 v[42:57], v[110:113], v[34:37], v[42:57]
    buffer_load_dwordx4 v115, s[36:39], s48 offen offset:1024 sc1 lds
    s_add_u32 s59, s59, 16384
    s_and_b32 s59, s59, 0x3ffff
    s_add_u32 s48, s58, s59
    v_exp_f32 v31, v31
    v_exp_f32 v32, v32
    v_cvt_pk_bf16_f32 v40, v30, v31
    v_exp_f32 v33, v33
    s_waitcnt lgkmcnt(0)
    v_cvt_pk_bf16_f32 v41, v32, v33
    s_waitcnt vmcnt(2)
    s_barrier
    v_mfma_f32_32x32x16_bf16 v[18:33], v[82:85], v[74:77], v[58:73]
    ds_read_b128 v[98:101], v120 offset:16384
    v_exp_f32 v2, v2
    v_exp_f32 v3, v3
    v_exp_f32 v4, v4
    v_cvt_pk_bf16_f32 v34, v2, v3
    v_exp_f32 v5, v5
    v_exp_f32 v6, v6
    v_cvt_pk_bf16_f32 v35, v4, v5
    v_mfma_f32_32x32x16_bf16 v[42:57], v[86:89], v[38:41], v[42:57]
    ds_read_b128 v[106:109], v120 offset:17408
    v_exp_f32 v7, v7
    v_exp_f32 v8, v8
    v_cvt_pk_bf16_f32 v36, v6, v7
    v_exp_f32 v9, v9
    v_exp_f32 v10, v10
    v_cvt_pk_bf16_f32 v37, v8, v9
    v_mfma_f32_32x32x16_bf16 v[18:33], v[90:93], v[78:81], v[18:33]
    ds_read_b128 v[102:105], v120 offset:3072
    ds_read_b128 v[110:113], v120 offset:6144
    v_exp_f32 v11, v11
    v_exp_f32 v12, v12
    v_cvt_pk_bf16_f32 v38, v10, v11
    v_exp_f32 v13, v13
    v_exp_f32 v14, v14
    v_cvt_pk_bf16_f32 v39, v12, v13
    v_mfma_f32_32x32x16_bf16 v[42:57], v[94:97], v[34:37], v[42:57]
    s_add_u32 m0, s49, 49152
    s_nop 0
    buffer_load_dwordx4 v115, s[36:39], s48 offen offset:0 sc1 lds
    v_exp_f32 v15, v15
    v_exp_f32 v16, v16
    v_cvt_pk_bf16_f32 v40, v14, v15
    v_exp_f32 v17, v17
    s_waitcnt lgkmcnt(0)
    v_cvt_pk_bf16_f32 v41, v16, v17
    v_mfma_f32_32x32x16_bf16 v[2:17], v[98:101], v[74:77], v[58:73]
    ds_read_b128 v[82:85], v120 offset:20480
    v_exp_f32 v18, v18
    v_exp_f32 v19, v19
    v_exp_f32 v20, v20
    v_cvt_pk_bf16_f32 v34, v18, v19
    v_exp_f32 v21, v21
    v_exp_f32 v22, v22
    v_cvt_pk_bf16_f32 v35, v20, v21
    v_mfma_f32_32x32x16_bf16 v[42:57], v[102:105], v[38:41], v[42:57]
    ds_read_b128 v[90:93], v120 offset:21504
    v_exp_f32 v23, v23
    v_exp_f32 v24, v24
    v_cvt_pk_bf16_f32 v36, v22, v23
    v_exp_f32 v25, v25
    v_exp_f32 v26, v26
    v_cvt_pk_bf16_f32 v37, v24, v25
    v_mfma_f32_32x32x16_bf16 v[2:17], v[106:109], v[78:81], v[2:17]
    ds_read_b128 v[86:89], v120 offset:7168
    ds_read_b128 v[94:97], v120 offset:18432
    v_exp_f32 v27, v27
    v_exp_f32 v28, v28
    v_cvt_pk_bf16_f32 v38, v26, v27
    v_exp_f32 v29, v29
    v_exp_f32 v30, v30
    v_cvt_pk_bf16_f32 v39, v28, v29
    v_mfma_f32_32x32x16_bf16 v[42:57], v[110:113], v[34:37], v[42:57]
    buffer_load_dwordx4 v115, s[36:39], s48 offen offset:1024 sc1 lds
    s_add_u32 s59, s59, 16384
    s_and_b32 s59, s59, 0x3ffff
    s_add_u32 s48, s58, s59
    v_exp_f32 v31, v31
    v_exp_f32 v32, v32
    v_cvt_pk_bf16_f32 v40, v30, v31
    v_exp_f32 v33, v33
    s_waitcnt lgkmcnt(0)
    v_cvt_pk_bf16_f32 v41, v32, v33
    s_waitcnt vmcnt(2)
    s_barrier
    v_mfma_f32_32x32x16_bf16 v[18:33], v[82:85], v[74:77], v[58:73]
    ds_read_b128 v[98:101], v120 offset:32768
    v_exp_f32 v2, v2
    v_exp_f32 v3, v3
    v_exp_f32 v4, v4
    v_cvt_pk_bf16_f32 v34, v2, v3
    v_exp_f32 v5, v5
    v_exp_f32 v6, v6
    v_cvt_pk_bf16_f32 v35, v4, v5
    v_mfma_f32_32x32x16_bf16 v[42:57], v[86:89], v[38:41], v[42:57]
    ds_read_b128 v[106:109], v120 offset:33792
    v_exp_f32 v7, v7
    v_exp_f32 v8, v8
    v_cvt_pk_bf16_f32 v36, v6, v7
    v_exp_f32 v9, v9
    v_exp_f32 v10, v10
    v_cvt_pk_bf16_f32 v37, v8, v9
    v_mfma_f32_32x32x16_bf16 v[18:33], v[90:93], v[78:81], v[18:33]
    ds_read_b128 v[102:105], v120 offset:19456
    ds_read_b128 v[110:113], v120 offset:22528
    v_exp_f32 v11, v11
    v_exp_f32 v12, v12
    v_cvt_pk_bf16_f32 v38, v10, v11
    v_exp_f32 v13, v13
    v_exp_f32 v14, v14
    v_cvt_pk_bf16_f32 v39, v12, v13
    v_mfma_f32_32x32x16_bf16 v[42:57], v[94:97], v[34:37], v[42:57]
    v_exp_f32 v15, v15
    v_exp_f32 v16, v16
    v_cvt_pk_bf16_f32 v40, v14, v15
    v_exp_f32 v17, v17
    s_waitcnt lgkmcnt(0)
    v_cvt_pk_bf16_f32 v41, v16, v17
    v_mfma_f32_32x32x16_bf16 v[2:17], v[98:101], v[74:77], v[58:73]
    ds_read_b128 v[82:85], v120 offset:36864
    v_exp_f32 v18, v18
    v_exp_f32 v19, v19
    v_exp_f32 v20, v20
    v_cvt_pk_bf16_f32 v34, v18, v19
    v_exp_f32 v21, v21
    v_exp_f32 v22, v22
    v_cvt_pk_bf16_f32 v35, v20, v21
    v_mfma_f32_32x32x16_bf16 v[42:57], v[102:105], v[38:41], v[42:57]
    ds_read_b128 v[90:93], v120 offset:37888
    v_exp_f32 v23, v23
    v_exp_f32 v24, v24
    v_cvt_pk_bf16_f32 v36, v22, v23
    v_exp_f32 v25, v25
    v_exp_f32 v26, v26
    v_cvt_pk_bf16_f32 v37, v24, v25
    v_mfma_f32_32x32x16_bf16 v[2:17], v[106:109], v[78:81], v[2:17]
    ds_read_b128 v[86:89], v120 offset:23552
    ds_read_b128 v[94:97], v120 offset:34816
    v_exp_f32 v27, v27
    v_exp_f32 v28, v28
    v_cvt_pk_bf16_f32 v38, v26, v27
    v_exp_f32 v29, v29
    v_exp_f32 v30, v30
    v_cvt_pk_bf16_f32 v39, v28, v29
    v_mfma_f32_32x32x16_bf16 v[42:57], v[110:113], v[34:37], v[42:57]
    v_exp_f32 v31, v31
    v_exp_f32 v32, v32
    v_cvt_pk_bf16_f32 v40, v30, v31
    v_exp_f32 v33, v33
    s_waitcnt lgkmcnt(0)
    v_cvt_pk_bf16_f32 v41, v32, v33
    s_waitcnt vmcnt(0)
    s_barrier
    v_mfma_f32_32x32x16_bf16 v[18:33], v[82:85], v[74:77], v[58:73]
    ds_read_b128 v[98:101], v120 offset:49152
    v_exp_f32 v2, v2
    v_exp_f32 v3, v3
    v_exp_f32 v4, v4
    v_cvt_pk_bf16_f32 v34, v2, v3
    v_exp_f32 v5, v5
    v_exp_f32 v6, v6
    v_cvt_pk_bf16_f32 v35, v4, v5
    v_mfma_f32_32x32x16_bf16 v[42:57], v[86:89], v[38:41], v[42:57]
    ds_read_b128 v[106:109], v120 offset:50176
    v_exp_f32 v7, v7
    v_exp_f32 v8, v8
    v_cvt_pk_bf16_f32 v36, v6, v7
    v_exp_f32 v9, v9
    v_exp_f32 v10, v10
    v_cvt_pk_bf16_f32 v37, v8, v9
    v_mfma_f32_32x32x16_bf16 v[18:33], v[90:93], v[78:81], v[18:33]
    ds_read_b128 v[102:105], v120 offset:35840
    ds_read_b128 v[110:113], v120 offset:38912
    v_exp_f32 v11, v11
    v_exp_f32 v12, v12
    v_cvt_pk_bf16_f32 v38, v10, v11
    v_exp_f32 v13, v13
    v_exp_f32 v14, v14
    v_cvt_pk_bf16_f32 v39, v12, v13
    v_mfma_f32_32x32x16_bf16 v[42:57], v[94:97], v[34:37], v[42:57]
    v_exp_f32 v15, v15
    v_exp_f32 v16, v16
    v_cvt_pk_bf16_f32 v40, v14, v15
    v_exp_f32 v17, v17
    s_waitcnt lgkmcnt(0)
    v_cvt_pk_bf16_f32 v41, v16, v17
    v_mfma_f32_32x32x16_bf16 v[2:17], v[98:101], v[74:77], v[58:73]
    ds_read_b128 v[82:85], v120 offset:53248
    v_exp_f32 v18, v18
    v_exp_f32 v19, v19
    v_exp_f32 v20, v20
    v_cvt_pk_bf16_f32 v34, v18, v19
    v_exp_f32 v21, v21
    v_exp_f32 v22, v22
    v_cvt_pk_bf16_f32 v35, v20, v21
    v_mfma_f32_32x32x16_bf16 v[42:57], v[102:105], v[38:41], v[42:57]
    ds_read_b128 v[90:93], v120 offset:54272
    v_exp_f32 v23, v23
    v_exp_f32 v24, v24
    v_cvt_pk_bf16_f32 v36, v22, v23
    v_exp_f32 v25, v25
    v_exp_f32 v26, v26
    v_cvt_pk_bf16_f32 v37, v24, v25
    v_mfma_f32_32x32x16_bf16 v[2:17], v[106:109], v[78:81], v[2:17]
    ds_read_b128 v[86:89], v120 offset:39936
    ds_read_b128 v[94:97], v120 offset:51200
    v_exp_f32 v27, v27
    v_exp_f32 v28, v28
    v_cvt_pk_bf16_f32 v38, v26, v27
    v_exp_f32 v29, v29
    v_exp_f32 v30, v30
    v_cvt_pk_bf16_f32 v39, v28, v29
    v_mfma_f32_32x32x16_bf16 v[42:57], v[110:113], v[34:37], v[42:57]
    v_exp_f32 v31, v31
    v_exp_f32 v32, v32
    v_cvt_pk_bf16_f32 v40, v30, v31
    v_exp_f32 v33, v33
    s_waitcnt lgkmcnt(0)
    v_cvt_pk_bf16_f32 v41, v32, v33
    s_waitcnt vmcnt(0)
    s_barrier
    v_mfma_f32_32x32x16_bf16 v[18:33], v[82:85], v[74:77], v[58:73]
    v_exp_f32 v2, v2
    v_exp_f32 v3, v3
    v_exp_f32 v4, v4
    v_cvt_pk_bf16_f32 v34, v2, v3
    v_exp_f32 v5, v5
    v_exp_f32 v6, v6
    v_cvt_pk_bf16_f32 v35, v4, v5
    v_mfma_f32_32x32x16_bf16 v[42:57], v[86:89], v[38:41], v[42:57]
    v_exp_f32 v7, v7
    v_exp_f32 v8, v8
    v_cvt_pk_bf16_f32 v36, v6, v7
    v_exp_f32 v9, v9
    v_exp_f32 v10, v10
    v_cvt_pk_bf16_f32 v37, v8, v9
    v_mfma_f32_32x32x16_bf16 v[18:33], v[90:93], v[78:81], v[18:33]
    ds_read_b128 v[102:105], v120 offset:52224
    ds_read_b128 v[110:113], v120 offset:55296
    v_exp_f32 v11, v11
    v_exp_f32 v12, v12
    v_cvt_pk_bf16_f32 v38, v10, v11
    v_exp_f32 v13, v13
    v_exp_f32 v14, v14
    v_cvt_pk_bf16_f32 v39, v12, v13
    v_mfma_f32_32x32x16_bf16 v[42:57], v[94:97], v[34:37], v[42:57]
    v_exp_f32 v15, v15
    v_exp_f32 v16, v16
    v_cvt_pk_bf16_f32 v40, v14, v15
    v_exp_f32 v17, v17
    s_waitcnt lgkmcnt(0)
    v_cvt_pk_bf16_f32 v41, v16, v17
    v_exp_f32 v18, v18
    v_exp_f32 v19, v19
    v_exp_f32 v20, v20
    v_cvt_pk_bf16_f32 v34, v18, v19
    v_exp_f32 v21, v21
    v_exp_f32 v22, v22
    v_cvt_pk_bf16_f32 v35, v20, v21
    v_mfma_f32_32x32x16_bf16 v[42:57], v[102:105], v[38:41], v[42:57]
    v_exp_f32 v23, v23
    v_exp_f32 v24, v24
    v_cvt_pk_bf16_f32 v36, v22, v23
    v_exp_f32 v25, v25
    v_exp_f32 v26, v26
    v_cvt_pk_bf16_f32 v37, v24, v25
    ds_read_b128 v[86:89], v120 offset:56320
    v_exp_f32 v27, v27
    v_exp_f32 v28, v28
    v_cvt_pk_bf16_f32 v38, v26, v27
    v_exp_f32 v29, v29
    v_exp_f32 v30, v30
    v_cvt_pk_bf16_f32 v39, v28, v29
    v_mfma_f32_32x32x16_bf16 v[42:57], v[110:113], v[34:37], v[42:57]
    v_exp_f32 v31, v31
    v_exp_f32 v32, v32
    v_cvt_pk_bf16_f32 v40, v30, v31
    v_exp_f32 v33, v33
    s_waitcnt lgkmcnt(0)
    v_cvt_pk_bf16_f32 v41, v32, v33
    s_nop 1
    v_mfma_f32_32x32x16_bf16 v[42:57], v[86:89], v[38:41], v[42:57]
    s_and_b32 s53, s26, 3
    s_lshl_b32 s53, s53, 12
    s_add_u32 s53, s53, 65536
    v_add_u32 v120, s53, v114
    s_cmp_lt_u32 s26, 4
    s_cbranch_scc1 att_lo
    s_nop 7
    ds_write_b128 v120, v[42:45] offset:0
    ds_write_b128 v120, v[46:49] offset:1024
    ds_write_b128 v120, v[50:53] offset:2048
    ds_write_b128 v120, v[54:57] offset:3072
    s_waitcnt lgkmcnt(0)
    s_barrier
    s_branch a_end
att_lo:
    s_barrier
    ds_read_b128 v[2:5], v120 offset:0
    ds_read_b128 v[6:9], v120 offset:1024
    ds_read_b128 v[10:13], v120 offset:2048
    ds_read_b128 v[14:17], v120 offset:3072
    s_waitcnt lgkmcnt(0)
    v_pk_add_f32 v[42:43], v[42:43], v[2:3]
    v_pk_add_f32 v[44:45], v[44:45], v[4:5]
    v_pk_add_f32 v[46:47], v[46:47], v[6:7]
    v_pk_add_f32 v[48:49], v[48:49], v[8:9]
    v_pk_add_f32 v[50:51], v[50:51], v[10:11]
    v_pk_add_f32 v[52:53], v[52:53], v[12:13]
    v_pk_add_f32 v[54:55], v[54:55], v[14:15]
    v_pk_add_f32 v[56:57], v[56:57], v[16:17]
att_fin:
    s_lshl_b32 s53, s27, 17
    s_lshl_b32 s54, s57, 9
    s_add_u32 s53, s53, s54
    s_add_u32 s53, s53, 10485760
    s_add_u32 s54, s53, 65536
    v_and_b32 v118, 31, v1
    v_lshrrev_b32 v119, 5, v1
    v_lshlrev_b32 v118, 4, v118
    v_lshl_add_u32 v118, v119, 15, v118
    s_nop 1
    v_mov_b32 v116, v54
    v_mov_b32 v117, v54
    s_nop 1
    v_permlane32_swap_b32 v116, v117
    s_mov_b32 exec_lo, 0
    v_mov_b32 v54, 0
    v_mov_b32 v55, 0
    v_mov_b32 v56, 0
    v_mov_b32 v57, 0
    s_mov_b64 exec, -1
    s_mov_b32 s59, 0x71800000
    v_add_f32_e64 v116, abs(v42), v117
    v_add_f32_e64 v116, abs(v43), v116
    v_add_f32_e64 v116, abs(v44), v116
    v_add_f32_e64 v116, abs(v45), v116
    v_add_f32_e64 v116, abs(v46), v116
    v_add_f32_e64 v116, abs(v47), v116
    v_add_f32_e64 v116, abs(v48), v116
    v_add_f32_e64 v116, abs(v49), v116
    v_add_f32_e64 v116, abs(v50), v116
    v_add_f32_e64 v116, abs(v51), v116
    v_add_f32_e64 v116, abs(v52), v116
    v_add_f32_e64 v116, abs(v53), v116
    v_add_f32_e64 v116, abs(v54), v116
    v_add_f32_e64 v116, abs(v55), v116
    v_add_f32_e64 v116, abs(v56), v116
    v_add_f32_e64 v116, abs(v57), v116
    v_cmp_nlt_f32_e64 vcc, v116, s59
    v_rcp_f32 v116, v117
    s_cmp_eq_u32 s58, 0
    s_cbranch_scc1 att_store
    s_cbranch_vccnz att_slow
att_store:
    v_mul_f32 v42, v42, v116
    v_mul_f32 v43, v43, v116
    v_mul_f32 v44, v44, v116
    v_mul_f32 v45, v45, v116
    v_mul_f32 v46, v46, v116
    v_mul_f32 v47, v47, v116
    v_mul_f32 v48, v48, v116
    v_mul_f32 v49, v49, v116
    v_mul_f32 v50, v50, v116
    v_mul_f32 v51, v51, v116
    v_mul_f32 v52, v52, v116
    v_mul_f32 v53, v53, v116
    v_mul_f32 v54, v54, v116
    v_mul_f32 v55, v55, v116
    v_mul_f32 v56, v56, v116
    v_mul_f32 v57, v57, v116
    v_cvt_pk_bf16_f32 v34, v42, v43
    v_cvt_pk_bf16_f32 v35, v44, v45
    v_cvt_pk_bf16_f32 v36, v46, v47
    v_cvt_pk_bf16_f32 v37, v48, v49
    v_cvt_pk_bf16_f32 v38, v50, v51
    v_cvt_pk_bf16_f32 v39, v52, v53
    v_cvt_pk_bf16_f32 v40, v54, v55
    v_cvt_pk_bf16_f32 v41, v56, v57
    buffer_store_dwordx4 v[34:37], v118, s[36:39], s53 offen sc1
    buffer_store_dwordx4 v[38:41], v118, s[36:39], s54 offen sc1
    s_branch a_end
att_slow:
    v_mov_b32 v116, 0xff800000
    s_mov_b32 s60, s58
    s_mov_b32 s61, 64
att_slow1:
    buffer_load_dwordx4 v[82:85], v114, s[36:39], s60 offen sc1
    buffer_load_dwordx4 v[86:89], v114, s[36:39], s60 offen offset:1024 sc1
    s_waitcnt vmcnt(0)
    v_mfma_f32_32x32x16_bf16 v[2:17], v[82:85], v[74:77], 0
    v_mfma_f32_32x32x16_bf16 v[2:17], v[86:89], v[78:81], v[2:17]
    s_nop 11
    v_max3_f32 v116, v116, v2, v3
    v_max3_f32 v116, v116, v4, v5
    v_max3_f32 v116, v116, v6, v7
    v_max3_f32 v116, v116, v8, v9
    v_max3_f32 v116, v116, v10, v11
    v_max3_f32 v116, v116, v12, v13
    v_max3_f32 v116, v116, v14, v15
    v_max3_f32 v116, v116, v16, v17
    s_add_u32 s60, s60, 4096
    s_sub_u32 s61, s61, 1
    s_cmp_lg_u32 s61, 0
    s_cbranch_scc1 att_slow1
    v_mov_b32 v117, v116
    s_nop 1
    v_permlane32_swap_b32 v116, v117
    v_max_f32 v116, v116, v117
    v_sub_f32 v58, 0, v116
    v_mov_b32 v59, v58
    v_mov_b32 v60, v58
    v_mov_b32 v61, v58
    v_mov_b32 v62, v58
    v_mov_b32 v63, v58
    v_mov_b32 v64, v58
    v_mov_b32 v65, v58
    v_mov_b32 v66, v58
    v_mov_b32 v67, v58
    v_mov_b32 v68, v58
    v_mov_b32 v69, v58
    v_mov_b32 v70, v58
    v_mov_b32 v71, v58
    v_mov_b32 v72, v58
    v_mov_b32 v73, v58
    v_mov_b32 v42, 0
    v_mov_b32 v43, 0
    v_mov_b32 v44, 0
    v_mov_b32 v45, 0
    v_mov_b32 v46, 0
    v_mov_b32 v47, 0
    v_mov_b32 v48, 0
    v_mov_b32 v49, 0
    v_mov_b32 v50, 0
    v_mov_b32 v51, 0
    v_mov_b32 v52, 0
    v_mov_b32 v53, 0
    v_mov_b32 v54, 0
    v_mov_b32 v55, 0
    v_mov_b32 v56, 0
    v_mov_b32 v57, 0
    s_mov_b32 s60, s58
    s_mov_b32 s61, 64
att_slow2:
    buffer_load_dwordx4 v[82:85], v114, s[36:39], s60 offen offset:0 sc1
    buffer_load_dwordx4 v[86:89], v114, s[36:39], s60 offen offset:1024 sc1
    buffer_load_dwordx4 v[90:93], v114, s[36:39], s60 offen offset:2048 sc1
    buffer_load_dwordx4 v[94:97], v114, s[36:39], s60 offen offset:3072 sc1
    s_waitcnt vmcnt(0)
    v_mfma_f32_32x32x16_bf16 v[2:17], v[82:85], v[74:77], v[58:73]
    v_mfma_f32_32x32x16_bf16 v[2:17], v[86:89], v[78:81], v[2:17]
    s_nop 11
    v_exp_f32 v2, v2
    v_exp_f32 v3, v3
    v_exp_f32 v4, v4
    v_exp_f32 v5, v5
    v_exp_f32 v6, v6
    v_exp_f32 v7, v7
    v_exp_f32 v8, v8
    v_exp_f32 v9, v9
    v_exp_f32 v10, v10
    v_exp_f32 v11, v11
    v_exp_f32 v12, v12
    v_exp_f32 v13, v13
    v_exp_f32 v14, v14
    v_exp_f32 v15, v15
    v_exp_f32 v16, v16
    v_exp_f32 v17, v17
    v_cvt_pk_bf16_f32 v34, v2, v3
    v_cvt_pk_bf16_f32 v35, v4, v5
    v_cvt_pk_bf16_f32 v36, v6, v7
    v_cvt_pk_bf16_f32 v37, v8, v9
    v_cvt_pk_bf16_f32 v38, v10, v11
    v_cvt_pk_bf16_f32 v39, v12, v13
    v_cvt_pk_bf16_f32 v40, v14, v15
    v_cvt_pk_bf16_f32 v41, v16, v17
    v_mfma_f32_32x32x16_bf16 v[42:57], v[90:93], v[34:37], v[42:57]
    s_nop 0
    v_mfma_f32_32x32x16_bf16 v[42:57], v[94:97], v[38:41], v[42:57]
    s_add_u32 s60, s60, 4096
    s_sub_u32 s61, s61, 1
    s_cmp_lg_u32 s61, 0
    s_cbranch_scc1 att_slow2
    s_mov_b32 s58, 0
    s_nop 7
    s_branch att_fin
a_end:
    s_waitcnt vmcnt(0)
    s_barrier
    s_cmp_lg_u32 s26, 4
    s_cbranch_scc1 a_exit
    s_lshl_b32 s53, s47, 4
    s_add_u32 s53, s53, s27
    s_lshl_b32 s53, s53, 7
    s_add_u32 s44, s53, 12681216
    v_mov_b32 v40, s46
    v_lshlrev_b32 v41, 2, v1
    s_mov_b32 exec_hi, 0
    buffer_store_dword v40, v41, s[36:39], s44 offen sc1
    s_mov_b32 exec_hi, -1
a_exit:
    s_endpgm
    .p2align 10
k_end:
.section .rodata,"a"
.p2align 6
.amdhsa_kernel parallel_sum__softmax_full_mha__mixer_token_mlp__prompt_kernel
  .amdhsa_next_free_vgpr 128
  .amdhsa_next_free_sgpr 72
  .amdhsa_accum_offset 128
  .amdhsa_group_segment_fixed_size 0
  .amdhsa_kernarg_size 88
  .amdhsa_user_sgpr_count 2
  .amdhsa_user_sgpr_kernarg_segment_ptr 1
  .amdhsa_system_sgpr_workgroup_id_x 1
.end_amdhsa_kernel
```
